```python
import torch

def _softmax(x, axis=-1):
    return torch.softmax(x, dim=axis)
def _gelu(x):
    return torch.nn.functional.gelu(x, approximate="tanh")
def _silu(x):
    return torch.nn.functional.silu(x)
def _sigmoid(x):
    return torch.sigmoid(x)
def _layernorm(x, axis=-1, eps=1e-5):
    m = x.mean(dim=axis, keepdim=True)
    v = x.var(dim=axis, keepdim=True, unbiased=False)
    return (x - m) / torch.sqrt(v + eps)
def _scatter_add(tgt, idx, src, axis=0):
    return tgt.clone().index_add_(axis, idx, src)
def _segment_sum(src, seg, n):
    out = torch.zeros((n,) + src.shape[1:], dtype=src.dtype)
    return out.index_add_(0, seg, src)
def _pad(x, pw):
    flat = tuple(v for pair in reversed(pw) for v in pair)
    return torch.nn.functional.pad(x, flat)

kernel_name = 'concat_heads__spectral_gfnet__softmax_full_mha__prompt'

def setup_inputs():

    _w = (lambda a: (lambda t: t.to(torch.bfloat16) if t.is_floating_point() else t)(torch.as_tensor(a)))
    def _A_setup():
        B, S, D = 1, 2048, 448
        Df = D // 2 + 1
        return {
            "x": _w((lambda *s: torch.randn(*s, dtype=torch.bfloat16) * 0.05)(B, S, D)),
            "w_r": _w((lambda *s: torch.randn(*s, dtype=torch.bfloat16) * 6.4)(S, Df) * 0.02),
            "w_i": _w((lambda *s: torch.randn(*s, dtype=torch.bfloat16) * 6.4)(S, Df) * 0.02),
        }
    _A_in = _A_setup()

    def _B_setup():
        B, S, D = 1, 2048, 448
        return {
            "x": _w((lambda *s: torch.randn(*s, dtype=torch.bfloat16) * 0.2)(B, S, D)),
            "wqkv": _w((lambda *s: torch.randn(*s, dtype=torch.bfloat16) * 0.2)(D, 3 * D)),
            "wo": _w((lambda *s: torch.randn(*s, dtype=torch.bfloat16) * 0.05)(D, D)),
        }
    _B_in = _B_setup()

    return {
        "A_x": _A_in["x"],
        "A_w_r": _A_in["w_r"],
        "A_w_i": _A_in["w_i"],
        "B_x": _B_in["x"],
        "B_wqkv": _B_in["wqkv"],
        "B_wo": _B_in["wo"],
    }

def reference(A_x, A_w_r, A_w_i, B_x, B_wqkv, B_wo):
    def _A_ref(x, w_r, w_i):
        B, S, D = x.shape
        X = (lambda x, axes=(-2,-1): torch.fft.rfft2(x.float(), dim=axes))(x, axes=(-2, -1))
        W = w_r + 1j * w_i
        X = X * W
        y = (lambda x, s, axes=(-2,-1): torch.fft.irfft2(x, s=s, dim=axes).to(torch.bfloat16))(X, (S, D), axes=(-2, -1))
        return y

    def _B_ref(x, wqkv, wo):
        B, S, D = x.shape
        H = 16; Dh = D // H
        qkv = (lambda x, *d: x.permute(*d))((x @ wqkv).reshape(B, S, 3, H, Dh), 2, 0, 3, 1, 4)
        q, k, v = qkv[0], qkv[1], qkv[2]
        scale = Dh ** -0.5
        scores = torch.einsum("bhqd,bhkd->bhqk", q, k) * scale
        p = _softmax(scores, axis=-1)
        o = torch.einsum("bhqk,bhkd->bhqd", p, v)
        return (lambda x, *d: x.permute(*d))(o, 0, 2, 1, 3).reshape(B, S, D) @ wo

    a = _A_ref(A_x, A_w_r, A_w_i)
    b = _B_ref(B_x, B_wqkv, B_wo)
    return torch.concatenate([a, b], axis=-1)
```

```asm
; @launch grid=(256,1,1) block=(512,1,1) lds=160000
.amdgcn_target "amdgcn-amd-amdhsa--gfx950"
.text
.globl concat_heads__spectral_gfnet__softmax_full_mha__prompt_kernel
.p2align 8
.type concat_heads__spectral_gfnet__softmax_full_mha__prompt_kernel,@function
concat_heads__spectral_gfnet__softmax_full_mha__prompt_kernel:
    s_cmp_ge_u32 s2, 256
    s_cbranch_scc1 L_end
    s_load_dwordx16 s[4:19], s[0:1], 0
    s_load_dwordx2 s[20:21], s[0:1], 64
    s_lshr_b32 s58, s2, 3
    s_getpc_b64 s[70:71]
L_pc:
    v_lshrrev_b32 v3, 5, v0
    v_lshl_add_u32 v3, s58, 4, v3
    v_lshlrev_b32 v3, 7, v3
    v_min_u32 v3, L_codeend-L_pc-4, v3
    global_load_dword v255, v3, s[70:71]
    v_lshrrev_b32 v2, 6, v0
    v_and_b32 v1, 63, v0
    v_readfirstlane_b32 s56, v2
    s_and_b32 s57, s2, 7
    s_and_b32 s52, s58, 7
    s_lshr_b32 s53, s58, 3
    s_and_b32 s59, s57, 3
    s_lshl_b32 s59, s59, 2
    s_and_b32 s66, s58, 3
    s_add_u32 s59, s59, s66
    s_lshl_b32 s66, s59, 2
    s_cmp_lt_u32 s59, 8
    s_cselect_b32 s3, 0x37a29810, s2
    s_cselect_b32 s3, s3, 0xed65c4fb
    s_lshr_b32 s3, s3, s66
    s_bfe_u32 s23, s3, 0x10003
    s_and_b32 s3, s3, 7
    s_lshr_b32 s60, s57, 2
    s_lshl_b32 s60, s60, 3
    s_lshr_b32 s66, s58, 2
    s_add_u32 s60, s60, s66
    s_and_b32 s61, s56, 3
    s_cmp_ge_u32 s56, 4
    s_cbranch_scc1 L_roleA
    s_setprio 3
    s_and_b32 s53, s60, 3
    s_and_b32 s52, s59, 7
    s_mul_i32 s54, s23, 7
    s_add_u32 s54, s54, s3
    v_lshrrev_b32 v8, 3, v1
    v_and_b32 v9, 7, v1
    v_mul_u32_u24 v2, 2688, v8
    v_bfe_u32 v3, v1, 4, 1
    v_lshlrev_b32 v3, 2, v3
    v_xor_b32 v3, v9, v3
    v_lshl_add_u32 v2, v3, 4, v2
    s_lshl_b32 s66, s54, 7
    s_mul_i32 s67, s61, 21504
    s_add_u32 s66, s66, s67
    s_add_u32 s66, s66, 896
    v_add_u32 v2, s66, v2
    s_lshl_b32 s68, s53, 3
    s_lshr_b32 s66, 3597469552, s68
    s_bfe_u32 s67, s66, 0x40004
    s_and_b32 s66, s66, 15
    s_lshl_b32 s69, s61, 10
    s_lshl_b32 s68, s66, 12
    s_add_u32 m0, s68, s69
    s_mul_i32 s79, s66, 86016
    s_lshl_b32 s68, s67, 12
    s_add_u32 s80, s68, s69
    s_mul_i32 s81, s67, 86016
    s_cmp_ge_u32 s53, 2
    s_cselect_b32 s66, -1, 1
    s_lshl_b32 s82, s66, 12
    s_mul_i32 s83, s66, 86016
    s_cmp_eq_u32 s3, 7
    s_cselect_b32 s30, 0, 1204224
    s_mov_b32 s31, 0x20000
    s_waitcnt lgkmcnt(0)
    s_mov_b64 s[28:29], s[12:13]
    buffer_load_dwordx4 v2, s[28:31], s79 offen lds
    s_add_u32 m0, m0, s82
    s_add_u32 s79, s79, s83
    buffer_load_dwordx4 v2, s[28:31], s79 offen lds
    s_add_u32 m0, m0, s82
    s_add_u32 s79, s79, s83
    buffer_load_dwordx4 v2, s[28:31], s79 offen lds
    s_add_u32 m0, m0, s82
    s_add_u32 s79, s79, s83
    buffer_load_dwordx4 v2, s[28:31], s79 offen lds
    s_add_u32 m0, m0, s82
    s_add_u32 s79, s79, s83
    buffer_load_dwordx4 v2, s[28:31], s79 offen lds
    s_add_u32 m0, m0, s82
    s_add_u32 s79, s79, s83
    buffer_load_dwordx4 v2, s[28:31], s79 offen lds
    s_add_u32 m0, m0, s82
    s_add_u32 s79, s79, s83
    buffer_load_dwordx4 v2, s[28:31], s79 offen lds
    s_mov_b32 s34, 1835008
    s_mov_b32 s35, 0x20000
    s_lshl_b32 s78, s60, 2
    s_add_u32 s78, s78, s61
    v_lshrrev_b32 v10, 4, v1
    v_xor_b32 v10, v9, v10
    v_xor_b32 v11, 4, v10
    v_mul_u32_u24 v12, 896, v8
    s_mul_i32 s68, s78, 28672
    v_add_u32 v12, s68, v12
    v_lshl_add_u32 v4, v10, 4, v12
    v_lshl_add_u32 v5, v11, 4, v12
    v_add_u32 v5, 7168, v5
    v_add_u32 v6, 14336, v4
    v_add_u32 v7, 14336, v5
    s_lshl_b32 s68, s52, 2
    s_lshr_b32 s70, 87122976, s68
    s_and_b32 s70, s70, 7
    s_lshl_b32 s70, s70, 7
    s_lshl_b32 s77, s61, 14
    s_add_u32 s77, s77, 86016
    s_mov_b64 s[32:33], s[10:11]
    s_add_u32 m0, s77, 0
    s_nop 0
    buffer_load_dwordx4 v4, s[32:35], s70 offen lds
    s_add_u32 m0, s77, 1024
    s_nop 0
    buffer_load_dwordx4 v5, s[32:35], s70 offen lds
    s_add_u32 m0, s77, 2048
    s_nop 0
    buffer_load_dwordx4 v6, s[32:35], s70 offen lds
    s_add_u32 m0, s77, 3072
    s_nop 0
    buffer_load_dwordx4 v7, s[32:35], s70 offen lds
    s_barrier
    s_load_dwordx2 s[62:63], s[20:21], 0
    s_mov_b32 m0, s80
    s_mov_b32 s79, s81
    s_add_u32 s71, s70, 128
    s_cmp_eq_u32 s71, 896
    s_cselect_b32 s71, 0, s71
    s_add_u32 s72, s71, 128
    s_cmp_eq_u32 s72, 896
    s_cselect_b32 s72, 0, s72
    s_add_u32 s73, s72, 128
    s_cmp_eq_u32 s73, 896
    s_cselect_b32 s73, 0, s73
    s_add_u32 s74, s73, 128
    s_cmp_eq_u32 s74, 896
    s_cselect_b32 s74, 0, s74
    s_add_u32 s75, s74, 128
    s_cmp_eq_u32 s75, 896
    s_cselect_b32 s75, 0, s75
    s_add_u32 s76, s75, 128
    s_cmp_eq_u32 s76, 896
    s_cselect_b32 s76, 0, s76
    v_and_b32 v12, 31, v1
    v_lshrrev_b32 v13, 5, v1
    v_bfe_u32 v14, v1, 1, 3
    v_xor_b32 v13, v13, v14
    v_lshlrev_b32 v12, 7, v12
    v_add_u32 v12, s77, v12
    v_xor_b32 v14, 0, v13
    v_lshl_add_u32 v8, v14, 4, v12
    v_xor_b32 v14, 2, v13
    v_lshl_add_u32 v9, v14, 4, v12
    v_xor_b32 v14, 4, v13
    v_lshl_add_u32 v10, v14, 4, v12
    v_xor_b32 v14, 6, v13
    v_lshl_add_u32 v11, v14, 4, v12
    s_mov_b32 s24, s20
    s_mov_b32 s25, s21
    s_mov_b32 s26, 16777216
    s_mov_b32 s27, 0x20000
    v_lshrrev_b32 v12, 5, v1
    v_lshlrev_b32 v12, 3, v12
    v_bfe_u32 v13, v1, 2, 2
    v_add_u32 v12, v12, v13
    v_bfe_u32 v13, v1, 4, 1
    v_lshlrev_b32 v13, 5, v13
    v_and_b32 v18, 1, v1
    v_bfe_u32 v19, v1, 1, 1
    v_lshl_add_u32 v15, v18, 4, v13
    v_lshl_add_u32 v15, v19, 3, v15
    v_lshl_add_u32 v14, v18, 3, v13
    v_lshl_add_u32 v14, v19, 4, v14
    s_cmp_eq_u32 s23, 1
    s_cselect_b64 vcc, -1, 0
    v_cndmask_b32 v14, v15, v14, vcc
    v_lshl_add_u32 v15, v12, 6, v15
    v_add_u32 v15, 57344, v15
    v_bfe_u32 v13, v1, 3, 1
    v_lshl_add_u32 v14, v13, 6, v14
    v_lshl_add_u32 v14, v12, 7, v14
    v_lshrrev_b32 v253, 2, v1
    v_mul_u32_u24 v253, 2688, v253
    v_and_b32 v254, 3, v1
    v_lshl_add_u32 v253, v254, 4, v253
    s_mul_i32 s55, s59, 7
    s_lshr_b32 s55, s55, 1
    s_lshl_b32 s80, s55, 4
    s_mul_i32 s81, s61, 43008
    s_add_u32 s80, s80, s81
    v_add_u32 v253, s80, v253
    s_lshl_b32 s80, s61, 10
    s_add_u32 s80, s80, 57344
    s_and_b32 s81, s55, 7
    s_cmp_gt_u32 s81, 4
    s_cselect_b32 s81, 1, 0
    s_nop 0
    v_lshl_add_u32 v12, s70, 6, v14
    v_xor_b32 v13, 64, v12
    v_mov_b32 v250, 159744
    v_mov_b32 v251, 1
    v_mov_b32 v246, 0
    s_mov_b32 s65, 0
    v_lshlrev_b32 v243, 4, v1
    s_lshl_b32 s66, s55, 9
    v_add_u32 v240, s66, v243
    s_lshl_b32 s66, s59, 11
    s_add_u32 s66, s66, 28672
    v_add_u32 v241, s66, v243
    s_lshr_b32 s67, s55, 3
    s_add_u32 s66, s55, 3
    s_lshr_b32 s66, s66, 3
    s_sub_u32 s66, s66, s67
    s_cmp_eq_u32 s66, 0
    s_cselect_b64 s[0:1], 5, 15
    v_and_b32 v242, 1, v1
    v_mul_u32_u24 v242, s66, v242
    v_bfe_u32 v18, v1, 1, 1
    v_mul_u32_u24 v18, 7, v18
    v_add_u32 v242, v242, v18
    v_lshlrev_b32 v242, 7, v242
    s_lshl_b32 s66, s61, 4
    s_add_u32 s66, s66, s67
    s_lshl_b32 s66, s66, 7
    s_add_u32 s69, s66, 131072
    s_and_b32 s68, s60, 3
    s_lshl_b32 s68, s68, 15
    s_add_u32 s69, s69, s68
    v_lshrrev_b32 v247, 4, v1
    v_lshlrev_b32 v247, 15, v247
    v_and_b32 v18, 15, v1
    v_lshl_add_u32 v247, v18, 3, v247
    s_lshr_b32 s68, s60, 2
    s_lshl_b32 s68, s68, 3
    s_lshr_b32 s68, 2471377380, s68
    s_mul_i32 s67, s61, 245760
    s_add_u32 s67, s67, 786432
    s_add_u32 s66, s53, 0
    s_and_b32 s66, s66, 3
    s_mul_i32 s48, s66, 61440
    s_add_u32 s66, s53, 1
    s_and_b32 s66, s66, 3
    s_mul_i32 s49, s66, 61440
    s_add_u32 s66, s53, 2
    s_and_b32 s66, s66, 3
    s_mul_i32 s50, s66, 61440
    s_add_u32 s66, s53, 3
    s_and_b32 s66, s66, 3
    s_mul_i32 s51, s66, 61440
    s_bfe_u32 s66, s68, 131072
    s_lshl_b32 s4, s66, 13
    s_add_u32 s4, s4, s69
    s_mul_i32 s66, s66, 983040
    s_add_u32 s66, s66, s67
    s_add_u32 s36, s66, 0
    s_add_u32 s37, s66, 61440
    s_add_u32 s38, s66, 122880
    s_add_u32 s39, s66, 184320
    s_bfe_u32 s66, s68, 131074
    s_lshl_b32 s5, s66, 13
    s_add_u32 s5, s5, s69
    s_mul_i32 s66, s66, 983040
    s_add_u32 s66, s66, s67
    s_add_u32 s40, s66, s48
    s_add_u32 s41, s66, s49
    s_add_u32 s42, s66, s50
    s_add_u32 s43, s66, s51
    s_bfe_u32 s66, s68, 131076
    s_lshl_b32 s6, s66, 13
    s_add_u32 s6, s6, s69
    s_mul_i32 s66, s66, 983040
    s_add_u32 s66, s66, s67
    s_add_u32 s44, s66, s48
    s_add_u32 s45, s66, s49
    s_add_u32 s46, s66, s50
    s_add_u32 s47, s66, s51
    s_bfe_u32 s66, s68, 131078
    s_lshl_b32 s7, s66, 13
    s_add_u32 s7, s7, s69
    s_mul_i32 s66, s66, 983040
    s_add_u32 s66, s66, s67
    s_add_u32 s48, s66, s48
    s_add_u32 s49, s66, s49
    s_add_u32 s50, s66, s50
    s_add_u32 s51, s66, s51
    s_cmp_eq_u32 s3, 7
    s_cselect_b32 s67, 15, s54
    s_lshl_b32 s66, s60, 4
    s_add_u32 s66, s66, s67
    s_lshl_b32 s66, s66, 7
    s_add_u32 s8, s66, 131072
    s_cmp_eq_u32 s23, 0
    s_cbranch_scc1 L_nopad
    s_lshl_b32 s67, s3, 2
    s_lshr_b32 s68, 0xDB96420, s67
    s_and_b32 s68, s68, 15
    s_lshr_b32 s69, 0x3223222, s67
    s_and_b32 s69, s69, 15
    s_lshl_b32 s69, s69, 4
    v_lshrrev_b32 v18, 2, v1
    v_lshlrev_b32 v18, 9, v18
    v_and_b32 v19, 3, v1
    v_lshl_add_u32 v18, v19, 4, v18
    s_lshl_b32 s68, s68, 11
    s_add_u32 s68, s68, 29120
    v_add_u32 v18, s68, v18
    v_cmp_eq_u32 vcc, 0, v19
    v_mov_b32 v19, 0x3f803f80
    s_nop 0
    v_cndmask_b32 v236, 0, v19, vcc
    v_cndmask_b32 v237, 0, v19, vcc
    v_cndmask_b32 v238, 0, v19, vcc
    v_cndmask_b32 v239, 0, v19, vcc
    s_mul_i32 s22, s78, 61440
    s_add_u32 s22, s22, 786432
    s_bfm_b64 exec, s69, 0
    buffer_store_dwordx4 v[236:239], v18, s[24:27], s22 offen sc1
    s_mov_b64 exec, -1
L_nopad:
    s_cmp_eq_u32 0, 0
    s_branch L_hop
L_hopd:
    buffer_load_dwordx4 v2, s[28:31], s79 offen lds
    s_add_u32 m0, m0, s82
    s_add_u32 s79, s79, s83
    buffer_load_dwordx4 v2, s[28:31], s79 offen lds
    s_add_u32 m0, m0, s82
    s_add_u32 s79, s79, s83
    buffer_load_dwordx4 v2, s[28:31], s79 offen lds
    s_add_u32 m0, m0, s82
    s_add_u32 s79, s79, s83
    buffer_load_dwordx4 v2, s[28:31], s79 offen lds
    s_add_u32 m0, m0, s82
    s_add_u32 s79, s79, s83
    buffer_load_dwordx4 v2, s[28:31], s79 offen lds
    s_add_u32 m0, m0, s82
    s_add_u32 s79, s79, s83
    buffer_load_dwordx4 v2, s[28:31], s79 offen lds
    s_add_u32 m0, m0, s82
    s_add_u32 s79, s79, s83
    buffer_load_dwordx4 v2, s[28:31], s79 offen lds
    s_waitcnt vmcnt(8)
    s_add_u32 m0, s77, 4096
    s_nop 0
    buffer_load_dwordx4 v4, s[32:35], s71 offen lds
    s_add_u32 m0, s77, 5120
    s_nop 0
    buffer_load_dwordx4 v5, s[32:35], s71 offen lds
    s_add_u32 m0, s77, 6144
    s_nop 0
    buffer_load_dwordx4 v6, s[32:35], s71 offen lds
    s_add_u32 m0, s77, 7168
    s_nop 0
    buffer_load_dwordx4 v7, s[32:35], s71 offen lds
    s_add_u32 m0, s77, 8192
    s_nop 0
    buffer_load_dwordx4 v4, s[32:35], s72 offen lds
    s_add_u32 m0, s77, 9216
    s_nop 0
    buffer_load_dwordx4 v5, s[32:35], s72 offen lds
    s_add_u32 m0, s77, 10240
    s_nop 0
    buffer_load_dwordx4 v6, s[32:35], s72 offen lds
    s_add_u32 m0, s77, 11264
    s_nop 0
    buffer_load_dwordx4 v7, s[32:35], s72 offen lds
    s_waitcnt lgkmcnt(0)
    s_mul_i32 s62, s62, 0x9E3779B1
    s_add_u32 s62, s62, 0x7F4A7C15
    s_mul_i32 s63, s63, 0x85EBCA6D
    s_add_u32 s63, s63, 0x165667B1
    v_mov_b32 v244, s62
    v_mov_b32 v245, s63
    ds_write_b64 v250, v[244:245] offset:64
    s_mov_b32 s30, 1204224
    s_cmp_eq_u32 s23, 1
    s_cbranch_scc1 L_kvV
    s_waitcnt vmcnt(8)
    s_mov_b64 exec, 1
    ds_add_u32 v250, v251
    s_mov_b64 exec, -1
    s_add_u32 m0, s77, 12288
    s_nop 0
    buffer_load_dwordx4 v4, s[32:35], s73 offen lds
    s_add_u32 m0, s77, 13312
    s_nop 0
    buffer_load_dwordx4 v5, s[32:35], s73 offen lds
    s_mov_b32 s64, 1048576
L_lw_1:
    ds_read_b32 v252, v250 offset:0
    s_waitcnt lgkmcnt(0)
    v_readfirstlane_b32 s66, v252
    s_cmp_ge_u32 s66, 4
    s_cbranch_scc1 L_lwd_2
    s_sub_u32 s64, s64, 1
    s_cbranch_scc0 L_lw_1
    s_mov_b32 s64, 19
    s_branch L_fail
L_lwd_2:
    ds_read_b64_tr_b16 v[160:161], v12 offset:0
    ds_read_b64_tr_b16 v[162:163], v12 offset:512
    ds_read_b64_tr_b16 v[164:165], v13 offset:0
    ds_read_b64_tr_b16 v[166:167], v13 offset:512
    ds_read_b64_tr_b16 v[168:169], v12 offset:2048
    ds_read_b64_tr_b16 v[170:171], v12 offset:2560
    ds_read_b64_tr_b16 v[172:173], v13 offset:2048
    ds_read_b64_tr_b16 v[174:175], v13 offset:2560
    ds_read_b128 v[16:19], v8 offset:0
    ds_read_b128 v[20:23], v9 offset:0
    ds_read_b128 v[24:27], v10 offset:0
    ds_read_b128 v[28:31], v11 offset:0
    ds_read_b64_tr_b16 v[176:177], v12 offset:4096
    ds_read_b64_tr_b16 v[178:179], v12 offset:4608
    ds_read_b64_tr_b16 v[180:181], v13 offset:4096
    ds_read_b64_tr_b16 v[182:183], v13 offset:4608
    ds_read_b64_tr_b16 v[184:185], v12 offset:6144
    ds_read_b64_tr_b16 v[186:187], v12 offset:6656
    ds_read_b64_tr_b16 v[188:189], v13 offset:6144
    ds_read_b64_tr_b16 v[190:191], v13 offset:6656
    s_waitcnt lgkmcnt(0)
    s_add_u32 m0, s77, 14336
    v_mfma_f32_32x32x16_bf16 v[128:143], v[160:163], v[16:19], 0
    buffer_load_dwordx4 v6, s[32:35], s73 offen lds
    v_lshl_add_u32 v12, s71, 6, v14
    v_xor_b32 v13, 64, v12
    ds_read_b64_tr_b16 v[192:193], v12 offset:0
    ds_read_b64_tr_b16 v[194:195], v12 offset:512
    ds_read_b64_tr_b16 v[196:197], v13 offset:0
    v_mfma_f32_32x32x16_bf16 v[144:159], v[164:167], v[16:19], 0
    ds_read_b64_tr_b16 v[198:199], v13 offset:512
    ds_read_b64_tr_b16 v[200:201], v12 offset:2048
    ds_read_b64_tr_b16 v[202:203], v12 offset:2560
    ds_read_b64_tr_b16 v[204:205], v13 offset:2048
    ds_read_b64_tr_b16 v[206:207], v13 offset:2560
    v_mfma_f32_32x32x16_bf16 v[128:143], v[168:171], v[20:23], v[128:143]
    ds_read_b64_tr_b16 v[208:209], v12 offset:4096
    ds_read_b64_tr_b16 v[210:211], v12 offset:4608
    ds_read_b64_tr_b16 v[212:213], v13 offset:4096
    ds_read_b64_tr_b16 v[214:215], v13 offset:4608
    v_mfma_f32_32x32x16_bf16 v[144:159], v[172:175], v[20:23], v[144:159]
    ds_read_b64_tr_b16 v[216:217], v12 offset:6144
    ds_read_b64_tr_b16 v[218:219], v12 offset:6656
    ds_read_b64_tr_b16 v[220:221], v13 offset:6144
    ds_read_b64_tr_b16 v[222:223], v13 offset:6656
    v_mfma_f32_32x32x16_bf16 v[128:143], v[176:179], v[24:27], v[128:143]
    s_waitcnt vmcnt(7)
    ds_read_b128 v[32:35], v8 offset:4096
    ds_read_b128 v[36:39], v9 offset:4096
    ds_read_b128 v[40:43], v10 offset:4096
    ds_read_b128 v[44:47], v11 offset:4096
    s_add_u32 m0, s77, 15360
    v_mfma_f32_32x32x16_bf16 v[144:159], v[180:183], v[24:27], v[144:159]
    buffer_load_dwordx4 v7, s[32:35], s73 offen lds
    s_add_u32 m0, s77, 0
    v_mfma_f32_32x32x16_bf16 v[128:143], v[184:187], v[28:31], v[128:143]
    buffer_load_dwordx4 v4, s[32:35], s74 offen lds
    s_add_u32 m0, s77, 1024
    v_mfma_f32_32x32x16_bf16 v[144:159], v[188:191], v[28:31], v[144:159]
    buffer_load_dwordx4 v5, s[32:35], s74 offen lds
    s_waitcnt lgkmcnt(0)
    s_add_u32 m0, s77, 2048
    v_mfma_f32_32x32x16_bf16 v[128:143], v[192:195], v[32:35], v[128:143]
    buffer_load_dwordx4 v6, s[32:35], s74 offen lds
    v_lshl_add_u32 v12, s72, 6, v14
    v_xor_b32 v13, 64, v12
    ds_read_b64_tr_b16 v[160:161], v12 offset:0
    ds_read_b64_tr_b16 v[162:163], v12 offset:512
    ds_read_b64_tr_b16 v[164:165], v13 offset:0
    v_mfma_f32_32x32x16_bf16 v[144:159], v[196:199], v[32:35], v[144:159]
    ds_read_b64_tr_b16 v[166:167], v13 offset:512
    ds_read_b64_tr_b16 v[168:169], v12 offset:2048
    ds_read_b64_tr_b16 v[170:171], v12 offset:2560
    ds_read_b64_tr_b16 v[172:173], v13 offset:2048
    ds_read_b64_tr_b16 v[174:175], v13 offset:2560
    v_mfma_f32_32x32x16_bf16 v[128:143], v[200:203], v[36:39], v[128:143]
    ds_read_b64_tr_b16 v[176:177], v12 offset:4096
    ds_read_b64_tr_b16 v[178:179], v12 offset:4608
    ds_read_b64_tr_b16 v[180:181], v13 offset:4096
    ds_read_b64_tr_b16 v[182:183], v13 offset:4608
    v_mfma_f32_32x32x16_bf16 v[144:159], v[204:207], v[36:39], v[144:159]
    ds_read_b64_tr_b16 v[184:185], v12 offset:6144
    ds_read_b64_tr_b16 v[186:187], v12 offset:6656
    ds_read_b64_tr_b16 v[188:189], v13 offset:6144
    ds_read_b64_tr_b16 v[190:191], v13 offset:6656
    v_mfma_f32_32x32x16_bf16 v[128:143], v[208:211], v[40:43], v[128:143]
    s_waitcnt vmcnt(7)
    ds_read_b128 v[48:51], v8 offset:8192
    ds_read_b128 v[52:55], v9 offset:8192
    ds_read_b128 v[56:59], v10 offset:8192
    ds_read_b128 v[60:63], v11 offset:8192
    s_add_u32 m0, s77, 3072
    v_mfma_f32_32x32x16_bf16 v[144:159], v[212:215], v[40:43], v[144:159]
    buffer_load_dwordx4 v7, s[32:35], s74 offen lds
    s_add_u32 m0, s77, 4096
    v_mfma_f32_32x32x16_bf16 v[128:143], v[216:219], v[44:47], v[128:143]
    buffer_load_dwordx4 v4, s[32:35], s75 offen lds
    s_add_u32 m0, s77, 5120
    v_mfma_f32_32x32x16_bf16 v[144:159], v[220:223], v[44:47], v[144:159]
    buffer_load_dwordx4 v5, s[32:35], s75 offen lds
    s_waitcnt lgkmcnt(0)
    s_add_u32 m0, s77, 6144
    v_mfma_f32_32x32x16_bf16 v[128:143], v[160:163], v[48:51], v[128:143]
    buffer_load_dwordx4 v6, s[32:35], s75 offen lds
    v_lshl_add_u32 v12, s73, 6, v14
    v_xor_b32 v13, 64, v12
    ds_read_b64_tr_b16 v[192:193], v12 offset:0
    ds_read_b64_tr_b16 v[194:195], v12 offset:512
    ds_read_b64_tr_b16 v[196:197], v13 offset:0
    v_mfma_f32_32x32x16_bf16 v[144:159], v[164:167], v[48:51], v[144:159]
    ds_read_b64_tr_b16 v[198:199], v13 offset:512
    ds_read_b64_tr_b16 v[200:201], v12 offset:2048
    ds_read_b64_tr_b16 v[202:203], v12 offset:2560
    ds_read_b64_tr_b16 v[204:205], v13 offset:2048
    ds_read_b64_tr_b16 v[206:207], v13 offset:2560
    v_mfma_f32_32x32x16_bf16 v[128:143], v[168:171], v[52:55], v[128:143]
    ds_read_b64_tr_b16 v[208:209], v12 offset:4096
    ds_read_b64_tr_b16 v[210:211], v12 offset:4608
    ds_read_b64_tr_b16 v[212:213], v13 offset:4096
    ds_read_b64_tr_b16 v[214:215], v13 offset:4608
    v_mfma_f32_32x32x16_bf16 v[144:159], v[172:175], v[52:55], v[144:159]
    ds_read_b64_tr_b16 v[216:217], v12 offset:6144
    ds_read_b64_tr_b16 v[218:219], v12 offset:6656
    ds_read_b64_tr_b16 v[220:221], v13 offset:6144
    ds_read_b64_tr_b16 v[222:223], v13 offset:6656
    v_mfma_f32_32x32x16_bf16 v[128:143], v[176:179], v[56:59], v[128:143]
    s_waitcnt vmcnt(7)
    ds_read_b128 v[64:67], v8 offset:12288
    ds_read_b128 v[68:71], v9 offset:12288
    ds_read_b128 v[72:75], v10 offset:12288
    ds_read_b128 v[76:79], v11 offset:12288
    s_add_u32 m0, s77, 7168
    v_mfma_f32_32x32x16_bf16 v[144:159], v[180:183], v[56:59], v[144:159]
    buffer_load_dwordx4 v7, s[32:35], s75 offen lds
    s_add_u32 m0, s77, 8192
    v_mfma_f32_32x32x16_bf16 v[128:143], v[184:187], v[60:63], v[128:143]
    buffer_load_dwordx4 v4, s[32:35], s76 offen lds
    s_add_u32 m0, s77, 9216
    v_mfma_f32_32x32x16_bf16 v[144:159], v[188:191], v[60:63], v[144:159]
    buffer_load_dwordx4 v5, s[32:35], s76 offen lds
    s_waitcnt lgkmcnt(0)
    s_add_u32 m0, s77, 10240
    v_mfma_f32_32x32x16_bf16 v[128:143], v[192:195], v[64:67], v[128:143]
    buffer_load_dwordx4 v6, s[32:35], s76 offen lds
    v_lshl_add_u32 v12, s74, 6, v14
    v_xor_b32 v13, 64, v12
    ds_read_b64_tr_b16 v[160:161], v12 offset:0
    ds_read_b64_tr_b16 v[162:163], v12 offset:512
    ds_read_b64_tr_b16 v[164:165], v13 offset:0
    v_mfma_f32_32x32x16_bf16 v[144:159], v[196:199], v[64:67], v[144:159]
    ds_read_b64_tr_b16 v[166:167], v13 offset:512
    ds_read_b64_tr_b16 v[168:169], v12 offset:2048
    ds_read_b64_tr_b16 v[170:171], v12 offset:2560
    ds_read_b64_tr_b16 v[172:173], v13 offset:2048
    ds_read_b64_tr_b16 v[174:175], v13 offset:2560
    v_mfma_f32_32x32x16_bf16 v[128:143], v[200:203], v[68:71], v[128:143]
    ds_read_b64_tr_b16 v[176:177], v12 offset:4096
    ds_read_b64_tr_b16 v[178:179], v12 offset:4608
    ds_read_b64_tr_b16 v[180:181], v13 offset:4096
    ds_read_b64_tr_b16 v[182:183], v13 offset:4608
    v_mfma_f32_32x32x16_bf16 v[144:159], v[204:207], v[68:71], v[144:159]
    ds_read_b64_tr_b16 v[184:185], v12 offset:6144
    ds_read_b64_tr_b16 v[186:187], v12 offset:6656
    ds_read_b64_tr_b16 v[188:189], v13 offset:6144
    ds_read_b64_tr_b16 v[190:191], v13 offset:6656
    v_mfma_f32_32x32x16_bf16 v[128:143], v[208:211], v[72:75], v[128:143]
    s_waitcnt vmcnt(7)
    ds_read_b128 v[80:83], v8 offset:0
    ds_read_b128 v[84:87], v9 offset:0
    ds_read_b128 v[88:91], v10 offset:0
    ds_read_b128 v[92:95], v11 offset:0
    s_add_u32 m0, s77, 11264
    v_mfma_f32_32x32x16_bf16 v[144:159], v[212:215], v[72:75], v[144:159]
    buffer_load_dwordx4 v7, s[32:35], s76 offen lds
    v_mfma_f32_32x32x16_bf16 v[128:143], v[216:219], v[76:79], v[128:143]
    v_mfma_f32_32x32x16_bf16 v[144:159], v[220:223], v[76:79], v[144:159]
    s_waitcnt lgkmcnt(0)
    v_mfma_f32_32x32x16_bf16 v[128:143], v[160:163], v[80:83], v[128:143]
    s_mov_b64 exec, 1
    ds_add_u32 v250, v251 offset:8
    s_mov_b64 exec, -1
    v_lshl_add_u32 v12, s75, 6, v14
    v_xor_b32 v13, 64, v12
    ds_read_b64_tr_b16 v[192:193], v12 offset:0
    ds_read_b64_tr_b16 v[194:195], v12 offset:512
    ds_read_b64_tr_b16 v[196:197], v13 offset:0
    v_mfma_f32_32x32x16_bf16 v[144:159], v[164:167], v[80:83], v[144:159]
    ds_read_b64_tr_b16 v[198:199], v13 offset:512
    ds_read_b64_tr_b16 v[200:201], v12 offset:2048
    ds_read_b64_tr_b16 v[202:203], v12 offset:2560
    ds_read_b64_tr_b16 v[204:205], v13 offset:2048
    ds_read_b64_tr_b16 v[206:207], v13 offset:2560
    s_add_u32 m0, s80, 0
    s_mul_i32 s82, s70, 1344
    buffer_load_dwordx4 v253, s[28:31], s82 offen lds
    v_mfma_f32_32x32x16_bf16 v[128:143], v[168:171], v[84:87], v[128:143]
    ds_read_b64_tr_b16 v[208:209], v12 offset:4096
    ds_read_b64_tr_b16 v[210:211], v12 offset:4608
    ds_read_b64_tr_b16 v[212:213], v13 offset:4096
    ds_read_b64_tr_b16 v[214:215], v13 offset:4608
    s_add_u32 m0, s80, 4096
    s_mul_i32 s82, s71, 1344
    buffer_load_dwordx4 v253, s[28:31], s82 offen lds
    v_mfma_f32_32x32x16_bf16 v[144:159], v[172:175], v[84:87], v[144:159]
    ds_read_b64_tr_b16 v[216:217], v12 offset:6144
    ds_read_b64_tr_b16 v[218:219], v12 offset:6656
    ds_read_b64_tr_b16 v[220:221], v13 offset:6144
    ds_read_b64_tr_b16 v[222:223], v13 offset:6656
    v_mfma_f32_32x32x16_bf16 v[128:143], v[176:179], v[88:91], v[128:143]
    s_waitcnt vmcnt(6)
    ds_read_b128 v[96:99], v8 offset:4096
    ds_read_b128 v[100:103], v9 offset:4096
    ds_read_b128 v[104:107], v10 offset:4096
    ds_read_b128 v[108:111], v11 offset:4096
    v_mfma_f32_32x32x16_bf16 v[144:159], v[180:183], v[88:91], v[144:159]
    s_mul_i32 s22, s78, 61440
    s_add_u32 s22, s22, 786432
    v_lshlrev_b32 v7, 4, v1
    s_lshl_b32 s66, s3, 12
    s_add_u32 s22, s22, s66
    v_mfma_f32_32x32x16_bf16 v[128:143], v[184:187], v[92:95], v[128:143]
    v_mfma_f32_32x32x16_bf16 v[144:159], v[188:191], v[92:95], v[144:159]
    s_waitcnt lgkmcnt(0)
    v_mfma_f32_32x32x16_bf16 v[128:143], v[192:195], v[96:99], v[128:143]
    v_lshl_add_u32 v12, s76, 6, v14
    v_xor_b32 v13, 64, v12
    ds_read_b64_tr_b16 v[160:161], v12 offset:0
    ds_read_b64_tr_b16 v[162:163], v12 offset:512
    ds_read_b64_tr_b16 v[164:165], v13 offset:0
    v_mfma_f32_32x32x16_bf16 v[144:159], v[196:199], v[96:99], v[144:159]
    ds_read_b64_tr_b16 v[166:167], v13 offset:512
    ds_read_b64_tr_b16 v[168:169], v12 offset:2048
    ds_read_b64_tr_b16 v[170:171], v12 offset:2560
    ds_read_b64_tr_b16 v[172:173], v13 offset:2048
    ds_read_b64_tr_b16 v[174:175], v13 offset:2560
    v_mfma_f32_32x32x16_bf16 v[128:143], v[200:203], v[100:103], v[128:143]
    ds_read_b64_tr_b16 v[176:177], v12 offset:4096
    ds_read_b64_tr_b16 v[178:179], v12 offset:4608
    ds_read_b64_tr_b16 v[180:181], v13 offset:4096
    ds_read_b64_tr_b16 v[182:183], v13 offset:4608
    v_mfma_f32_32x32x16_bf16 v[144:159], v[204:207], v[100:103], v[144:159]
    ds_read_b64_tr_b16 v[184:185], v12 offset:6144
    ds_read_b64_tr_b16 v[186:187], v12 offset:6656
    ds_read_b64_tr_b16 v[188:189], v13 offset:6144
    ds_read_b64_tr_b16 v[190:191], v13 offset:6656
    v_mfma_f32_32x32x16_bf16 v[128:143], v[208:211], v[104:107], v[128:143]
    s_waitcnt vmcnt(2)
    ds_read_b128 v[112:115], v8 offset:8192
    ds_read_b128 v[116:119], v9 offset:8192
    ds_read_b128 v[120:123], v10 offset:8192
    ds_read_b128 v[124:127], v11 offset:8192
    v_mfma_f32_32x32x16_bf16 v[144:159], v[212:215], v[104:107], v[144:159]
    v_mfma_f32_32x32x16_bf16 v[128:143], v[216:219], v[108:111], v[128:143]
    v_mfma_f32_32x32x16_bf16 v[144:159], v[220:223], v[108:111], v[144:159]
    s_waitcnt lgkmcnt(0)
    v_mfma_f32_32x32x16_bf16 v[128:143], v[160:163], v[112:115], v[128:143]
    v_mfma_f32_32x32x16_bf16 v[144:159], v[164:167], v[112:115], v[144:159]
    v_mfma_f32_32x32x16_bf16 v[128:143], v[168:171], v[116:119], v[128:143]
    v_mfma_f32_32x32x16_bf16 v[144:159], v[172:175], v[116:119], v[144:159]
    v_mfma_f32_32x32x16_bf16 v[128:143], v[176:179], v[120:123], v[128:143]
    v_mfma_f32_32x32x16_bf16 v[144:159], v[180:183], v[120:123], v[144:159]
    v_mfma_f32_32x32x16_bf16 v[128:143], v[184:187], v[124:127], v[128:143]
    v_mfma_f32_32x32x16_bf16 v[144:159], v[188:191], v[124:127], v[144:159]
    s_cmp_eq_u32 s3, 7
    s_cbranch_scc1 L_kvnone
    s_nop 8
    v_cvt_pk_bf16_f32 v224, v128, v129
    v_cvt_pk_bf16_f32 v225, v130, v131
    v_cvt_pk_bf16_f32 v226, v132, v133
    v_cvt_pk_bf16_f32 v227, v134, v135
    buffer_store_dwordx4 v[224:227], v7, s[24:27], s22 offen offset:0 sc0 sc1
    v_cvt_pk_bf16_f32 v228, v136, v137
    v_cvt_pk_bf16_f32 v229, v138, v139
    v_cvt_pk_bf16_f32 v230, v140, v141
    v_cvt_pk_bf16_f32 v231, v142, v143
    buffer_store_dwordx4 v[228:231], v7, s[24:27], s22 offen offset:1024 sc0 sc1
    v_cvt_pk_bf16_f32 v232, v144, v145
    v_cvt_pk_bf16_f32 v233, v146, v147
    v_cvt_pk_bf16_f32 v234, v148, v149
    v_cvt_pk_bf16_f32 v235, v150, v151
    buffer_store_dwordx4 v[232:235], v7, s[24:27], s22 offen offset:2048 sc0 sc1
    v_cvt_pk_bf16_f32 v236, v152, v153
    v_cvt_pk_bf16_f32 v237, v154, v155
    v_cvt_pk_bf16_f32 v238, v156, v157
    v_cvt_pk_bf16_f32 v239, v158, v159
    buffer_store_dwordx4 v[236:239], v7, s[24:27], s22 offen offset:3072 sc0 sc1
    s_branch L_kvdone
L_kvnone:
    s_waitcnt vmcnt(0)
    s_branch L_kvdone
L_kvV:
    s_waitcnt vmcnt(8)
    s_mov_b64 exec, 1
    ds_add_u32 v250, v251
    s_mov_b64 exec, -1
    s_add_u32 m0, s77, 12288
    s_nop 0
    buffer_load_dwordx4 v4, s[32:35], s73 offen lds
    s_add_u32 m0, s77, 13312
    s_nop 0
    buffer_load_dwordx4 v5, s[32:35], s73 offen lds
    s_mov_b32 s64, 1048576
L_lw_3:
    ds_read_b32 v252, v250 offset:0
    s_waitcnt lgkmcnt(0)
    v_readfirstlane_b32 s66, v252
    s_cmp_ge_u32 s66, 4
    s_cbranch_scc1 L_lwd_4
    s_sub_u32 s64, s64, 1
    s_cbranch_scc0 L_lw_3
    s_mov_b32 s64, 19
    s_branch L_fail
L_lwd_4:
    ds_read_b64_tr_b16 v[160:161], v12 offset:0
    ds_read_b64_tr_b16 v[162:163], v12 offset:512
    ds_read_b64_tr_b16 v[164:165], v13 offset:0
    ds_read_b64_tr_b16 v[166:167], v13 offset:512
    ds_read_b64_tr_b16 v[168:169], v12 offset:2048
    ds_read_b64_tr_b16 v[170:171], v12 offset:2560
    ds_read_b64_tr_b16 v[172:173], v13 offset:2048
    ds_read_b64_tr_b16 v[174:175], v13 offset:2560
    ds_read_b128 v[16:19], v8 offset:0
    ds_read_b128 v[20:23], v9 offset:0
    ds_read_b128 v[24:27], v10 offset:0
    ds_read_b128 v[28:31], v11 offset:0
    ds_read_b64_tr_b16 v[176:177], v12 offset:4096
    ds_read_b64_tr_b16 v[178:179], v12 offset:4608
    ds_read_b64_tr_b16 v[180:181], v13 offset:4096
    ds_read_b64_tr_b16 v[182:183], v13 offset:4608
    ds_read_b64_tr_b16 v[184:185], v12 offset:6144
    ds_read_b64_tr_b16 v[186:187], v12 offset:6656
    ds_read_b64_tr_b16 v[188:189], v13 offset:6144
    ds_read_b64_tr_b16 v[190:191], v13 offset:6656
    s_waitcnt lgkmcnt(0)
    s_add_u32 m0, s77, 14336
    v_mfma_f32_32x32x16_bf16 v[128:143], v[16:19], v[160:163], 0
    buffer_load_dwordx4 v6, s[32:35], s73 offen lds
    v_lshl_add_u32 v12, s71, 6, v14
    v_xor_b32 v13, 64, v12
    ds_read_b64_tr_b16 v[192:193], v12 offset:0
    ds_read_b64_tr_b16 v[194:195], v12 offset:512
    ds_read_b64_tr_b16 v[196:197], v13 offset:0
    v_mfma_f32_32x32x16_bf16 v[144:159], v[16:19], v[164:167], 0
    ds_read_b64_tr_b16 v[198:199], v13 offset:512
    ds_read_b64_tr_b16 v[200:201], v12 offset:2048
    ds_read_b64_tr_b16 v[202:203], v12 offset:2560
    ds_read_b64_tr_b16 v[204:205], v13 offset:2048
    ds_read_b64_tr_b16 v[206:207], v13 offset:2560
    v_mfma_f32_32x32x16_bf16 v[128:143], v[20:23], v[168:171], v[128:143]
    ds_read_b64_tr_b16 v[208:209], v12 offset:4096
    ds_read_b64_tr_b16 v[210:211], v12 offset:4608
    ds_read_b64_tr_b16 v[212:213], v13 offset:4096
    ds_read_b64_tr_b16 v[214:215], v13 offset:4608
    v_mfma_f32_32x32x16_bf16 v[144:159], v[20:23], v[172:175], v[144:159]
    ds_read_b64_tr_b16 v[216:217], v12 offset:6144
    ds_read_b64_tr_b16 v[218:219], v12 offset:6656
    ds_read_b64_tr_b16 v[220:221], v13 offset:6144
    ds_read_b64_tr_b16 v[222:223], v13 offset:6656
    v_mfma_f32_32x32x16_bf16 v[128:143], v[24:27], v[176:179], v[128:143]
    s_waitcnt vmcnt(7)
    ds_read_b128 v[32:35], v8 offset:4096
    ds_read_b128 v[36:39], v9 offset:4096
    ds_read_b128 v[40:43], v10 offset:4096
    ds_read_b128 v[44:47], v11 offset:4096
    s_add_u32 m0, s77, 15360
    v_mfma_f32_32x32x16_bf16 v[144:159], v[24:27], v[180:183], v[144:159]
    buffer_load_dwordx4 v7, s[32:35], s73 offen lds
    s_add_u32 m0, s77, 0
    v_mfma_f32_32x32x16_bf16 v[128:143], v[28:31], v[184:187], v[128:143]
    buffer_load_dwordx4 v4, s[32:35], s74 offen lds
    s_add_u32 m0, s77, 1024
    v_mfma_f32_32x32x16_bf16 v[144:159], v[28:31], v[188:191], v[144:159]
    buffer_load_dwordx4 v5, s[32:35], s74 offen lds
    s_waitcnt lgkmcnt(0)
    s_add_u32 m0, s77, 2048
    v_mfma_f32_32x32x16_bf16 v[128:143], v[32:35], v[192:195], v[128:143]
    buffer_load_dwordx4 v6, s[32:35], s74 offen lds
    v_lshl_add_u32 v12, s72, 6, v14
    v_xor_b32 v13, 64, v12
    ds_read_b64_tr_b16 v[160:161], v12 offset:0
    ds_read_b64_tr_b16 v[162:163], v12 offset:512
    ds_read_b64_tr_b16 v[164:165], v13 offset:0
    v_mfma_f32_32x32x16_bf16 v[144:159], v[32:35], v[196:199], v[144:159]
    ds_read_b64_tr_b16 v[166:167], v13 offset:512
    ds_read_b64_tr_b16 v[168:169], v12 offset:2048
    ds_read_b64_tr_b16 v[170:171], v12 offset:2560
    ds_read_b64_tr_b16 v[172:173], v13 offset:2048
    ds_read_b64_tr_b16 v[174:175], v13 offset:2560
    v_mfma_f32_32x32x16_bf16 v[128:143], v[36:39], v[200:203], v[128:143]
    ds_read_b64_tr_b16 v[176:177], v12 offset:4096
    ds_read_b64_tr_b16 v[178:179], v12 offset:4608
    ds_read_b64_tr_b16 v[180:181], v13 offset:4096
    ds_read_b64_tr_b16 v[182:183], v13 offset:4608
    v_mfma_f32_32x32x16_bf16 v[144:159], v[36:39], v[204:207], v[144:159]
    ds_read_b64_tr_b16 v[184:185], v12 offset:6144
    ds_read_b64_tr_b16 v[186:187], v12 offset:6656
    ds_read_b64_tr_b16 v[188:189], v13 offset:6144
    ds_read_b64_tr_b16 v[190:191], v13 offset:6656
    v_mfma_f32_32x32x16_bf16 v[128:143], v[40:43], v[208:211], v[128:143]
    s_waitcnt vmcnt(7)
    ds_read_b128 v[48:51], v8 offset:8192
    ds_read_b128 v[52:55], v9 offset:8192
    ds_read_b128 v[56:59], v10 offset:8192
    ds_read_b128 v[60:63], v11 offset:8192
    s_add_u32 m0, s77, 3072
    v_mfma_f32_32x32x16_bf16 v[144:159], v[40:43], v[212:215], v[144:159]
    buffer_load_dwordx4 v7, s[32:35], s74 offen lds
    s_add_u32 m0, s77, 4096
    v_mfma_f32_32x32x16_bf16 v[128:143], v[44:47], v[216:219], v[128:143]
    buffer_load_dwordx4 v4, s[32:35], s75 offen lds
    s_add_u32 m0, s77, 5120
    v_mfma_f32_32x32x16_bf16 v[144:159], v[44:47], v[220:223], v[144:159]
    buffer_load_dwordx4 v5, s[32:35], s75 offen lds
    s_waitcnt lgkmcnt(0)
    s_add_u32 m0, s77, 6144
    v_mfma_f32_32x32x16_bf16 v[128:143], v[48:51], v[160:163], v[128:143]
    buffer_load_dwordx4 v6, s[32:35], s75 offen lds
    v_lshl_add_u32 v12, s73, 6, v14
    v_xor_b32 v13, 64, v12
    ds_read_b64_tr_b16 v[192:193], v12 offset:0
    ds_read_b64_tr_b16 v[194:195], v12 offset:512
    ds_read_b64_tr_b16 v[196:197], v13 offset:0
    v_mfma_f32_32x32x16_bf16 v[144:159], v[48:51], v[164:167], v[144:159]
    ds_read_b64_tr_b16 v[198:199], v13 offset:512
    ds_read_b64_tr_b16 v[200:201], v12 offset:2048
    ds_read_b64_tr_b16 v[202:203], v12 offset:2560
    ds_read_b64_tr_b16 v[204:205], v13 offset:2048
    ds_read_b64_tr_b16 v[206:207], v13 offset:2560
    v_mfma_f32_32x32x16_bf16 v[128:143], v[52:55], v[168:171], v[128:143]
    ds_read_b64_tr_b16 v[208:209], v12 offset:4096
    ds_read_b64_tr_b16 v[210:211], v12 offset:4608
    ds_read_b64_tr_b16 v[212:213], v13 offset:4096
    ds_read_b64_tr_b16 v[214:215], v13 offset:4608
    v_mfma_f32_32x32x16_bf16 v[144:159], v[52:55], v[172:175], v[144:159]
    ds_read_b64_tr_b16 v[216:217], v12 offset:6144
    ds_read_b64_tr_b16 v[218:219], v12 offset:6656
    ds_read_b64_tr_b16 v[220:221], v13 offset:6144
    ds_read_b64_tr_b16 v[222:223], v13 offset:6656
    v_mfma_f32_32x32x16_bf16 v[128:143], v[56:59], v[176:179], v[128:143]
    s_waitcnt vmcnt(7)
    ds_read_b128 v[64:67], v8 offset:12288
    ds_read_b128 v[68:71], v9 offset:12288
    ds_read_b128 v[72:75], v10 offset:12288
    ds_read_b128 v[76:79], v11 offset:12288
    s_add_u32 m0, s77, 7168
    v_mfma_f32_32x32x16_bf16 v[144:159], v[56:59], v[180:183], v[144:159]
    buffer_load_dwordx4 v7, s[32:35], s75 offen lds
    s_add_u32 m0, s77, 8192
    v_mfma_f32_32x32x16_bf16 v[128:143], v[60:63], v[184:187], v[128:143]
    buffer_load_dwordx4 v4, s[32:35], s76 offen lds
    s_add_u32 m0, s77, 9216
    v_mfma_f32_32x32x16_bf16 v[144:159], v[60:63], v[188:191], v[144:159]
    buffer_load_dwordx4 v5, s[32:35], s76 offen lds
    s_waitcnt lgkmcnt(0)
    s_add_u32 m0, s77, 10240
    v_mfma_f32_32x32x16_bf16 v[128:143], v[64:67], v[192:195], v[128:143]
    buffer_load_dwordx4 v6, s[32:35], s76 offen lds
    v_lshl_add_u32 v12, s74, 6, v14
    v_xor_b32 v13, 64, v12
    ds_read_b64_tr_b16 v[160:161], v12 offset:0
    ds_read_b64_tr_b16 v[162:163], v12 offset:512
    ds_read_b64_tr_b16 v[164:165], v13 offset:0
    v_mfma_f32_32x32x16_bf16 v[144:159], v[64:67], v[196:199], v[144:159]
    ds_read_b64_tr_b16 v[166:167], v13 offset:512
    ds_read_b64_tr_b16 v[168:169], v12 offset:2048
    ds_read_b64_tr_b16 v[170:171], v12 offset:2560
    ds_read_b64_tr_b16 v[172:173], v13 offset:2048
    ds_read_b64_tr_b16 v[174:175], v13 offset:2560
    v_mfma_f32_32x32x16_bf16 v[128:143], v[68:71], v[200:203], v[128:143]
    ds_read_b64_tr_b16 v[176:177], v12 offset:4096
    ds_read_b64_tr_b16 v[178:179], v12 offset:4608
    ds_read_b64_tr_b16 v[180:181], v13 offset:4096
    ds_read_b64_tr_b16 v[182:183], v13 offset:4608
    v_mfma_f32_32x32x16_bf16 v[144:159], v[68:71], v[204:207], v[144:159]
    ds_read_b64_tr_b16 v[184:185], v12 offset:6144
    ds_read_b64_tr_b16 v[186:187], v12 offset:6656
    ds_read_b64_tr_b16 v[188:189], v13 offset:6144
    ds_read_b64_tr_b16 v[190:191], v13 offset:6656
    v_mfma_f32_32x32x16_bf16 v[128:143], v[72:75], v[208:211], v[128:143]
    s_waitcnt vmcnt(7)
    ds_read_b128 v[80:83], v8 offset:0
    ds_read_b128 v[84:87], v9 offset:0
    ds_read_b128 v[88:91], v10 offset:0
    ds_read_b128 v[92:95], v11 offset:0
    s_add_u32 m0, s77, 11264
    v_mfma_f32_32x32x16_bf16 v[144:159], v[72:75], v[212:215], v[144:159]
    buffer_load_dwordx4 v7, s[32:35], s76 offen lds
    v_mfma_f32_32x32x16_bf16 v[128:143], v[76:79], v[216:219], v[128:143]
    v_mfma_f32_32x32x16_bf16 v[144:159], v[76:79], v[220:223], v[144:159]
    s_waitcnt lgkmcnt(0)
    v_mfma_f32_32x32x16_bf16 v[128:143], v[80:83], v[160:163], v[128:143]
    s_mov_b64 exec, 1
    ds_add_u32 v250, v251 offset:8
    s_mov_b64 exec, -1
    v_lshl_add_u32 v12, s75, 6, v14
    v_xor_b32 v13, 64, v12
    ds_read_b64_tr_b16 v[192:193], v12 offset:0
    ds_read_b64_tr_b16 v[194:195], v12 offset:512
    ds_read_b64_tr_b16 v[196:197], v13 offset:0
    v_mfma_f32_32x32x16_bf16 v[144:159], v[80:83], v[164:167], v[144:159]
    ds_read_b64_tr_b16 v[198:199], v13 offset:512
    ds_read_b64_tr_b16 v[200:201], v12 offset:2048
    ds_read_b64_tr_b16 v[202:203], v12 offset:2560
    ds_read_b64_tr_b16 v[204:205], v13 offset:2048
    ds_read_b64_tr_b16 v[206:207], v13 offset:2560
    s_add_u32 m0, s80, 0
    s_mul_i32 s82, s70, 1344
    buffer_load_dwordx4 v253, s[28:31], s82 offen lds
    v_mfma_f32_32x32x16_bf16 v[128:143], v[84:87], v[168:171], v[128:143]
    ds_read_b64_tr_b16 v[208:209], v12 offset:4096
    ds_read_b64_tr_b16 v[210:211], v12 offset:4608
    ds_read_b64_tr_b16 v[212:213], v13 offset:4096
    ds_read_b64_tr_b16 v[214:215], v13 offset:4608
    s_add_u32 m0, s80, 4096
    s_mul_i32 s82, s71, 1344
    buffer_load_dwordx4 v253, s[28:31], s82 offen lds
    v_mfma_f32_32x32x16_bf16 v[144:159], v[84:87], v[172:175], v[144:159]
    ds_read_b64_tr_b16 v[216:217], v12 offset:6144
    ds_read_b64_tr_b16 v[218:219], v12 offset:6656
    ds_read_b64_tr_b16 v[220:221], v13 offset:6144
    ds_read_b64_tr_b16 v[222:223], v13 offset:6656
    v_mfma_f32_32x32x16_bf16 v[128:143], v[88:91], v[176:179], v[128:143]
    s_waitcnt vmcnt(6)
    ds_read_b128 v[96:99], v8 offset:4096
    ds_read_b128 v[100:103], v9 offset:4096
    ds_read_b128 v[104:107], v10 offset:4096
    ds_read_b128 v[108:111], v11 offset:4096
    v_mfma_f32_32x32x16_bf16 v[144:159], v[88:91], v[180:183], v[144:159]
    s_mul_i32 s22, s78, 61440
    s_add_u32 s22, s22, 786432
    v_lshlrev_b32 v7, 4, v1
    s_lshl_b32 s67, s3, 6
    v_and_b32 v4, 31, v1
    v_add_u32 v4, s67, v4
    v_mfma_f32_32x32x16_bf16 v[128:143], v[92:95], v[184:187], v[128:143]
    v_add_u32 v5, 32, v4
    v_lshrrev_b32 v3, 5, v1
    v_lshlrev_b32 v3, 9, v3
    v_add_u32 v3, 28672, v3
    v_mul_u32_u24 v2, 2341, v4
    v_lshrrev_b32 v2, 16, v2
    v_mfma_f32_32x32x16_bf16 v[144:159], v[92:95], v[188:191], v[144:159]
    v_mul_u32_u24 v2, 1600, v2
    v_lshl_add_u32 v4, v4, 4, v2
    v_add_u32 v4, v4, v3
    v_mul_u32_u24 v2, 2341, v5
    v_lshrrev_b32 v2, 16, v2
    v_mul_u32_u24 v2, 1600, v2
    s_waitcnt lgkmcnt(0)
    v_mfma_f32_32x32x16_bf16 v[128:143], v[96:99], v[192:195], v[128:143]
    v_lshl_add_u32 v12, s76, 6, v14
    v_xor_b32 v13, 64, v12
    ds_read_b64_tr_b16 v[160:161], v12 offset:0
    ds_read_b64_tr_b16 v[162:163], v12 offset:512
    ds_read_b64_tr_b16 v[164:165], v13 offset:0
    v_mfma_f32_32x32x16_bf16 v[144:159], v[96:99], v[196:199], v[144:159]
    ds_read_b64_tr_b16 v[166:167], v13 offset:512
    ds_read_b64_tr_b16 v[168:169], v12 offset:2048
    ds_read_b64_tr_b16 v[170:171], v12 offset:2560
    ds_read_b64_tr_b16 v[172:173], v13 offset:2048
    ds_read_b64_tr_b16 v[174:175], v13 offset:2560
    v_mfma_f32_32x32x16_bf16 v[128:143], v[100:103], v[200:203], v[128:143]
    ds_read_b64_tr_b16 v[176:177], v12 offset:4096
    ds_read_b64_tr_b16 v[178:179], v12 offset:4608
    ds_read_b64_tr_b16 v[180:181], v13 offset:4096
    ds_read_b64_tr_b16 v[182:183], v13 offset:4608
    v_mfma_f32_32x32x16_bf16 v[144:159], v[100:103], v[204:207], v[144:159]
    ds_read_b64_tr_b16 v[184:185], v12 offset:6144
    ds_read_b64_tr_b16 v[186:187], v12 offset:6656
    ds_read_b64_tr_b16 v[188:189], v13 offset:6144
    ds_read_b64_tr_b16 v[190:191], v13 offset:6656
    v_mfma_f32_32x32x16_bf16 v[128:143], v[104:107], v[208:211], v[128:143]
    s_waitcnt vmcnt(2)
    ds_read_b128 v[112:115], v8 offset:8192
    ds_read_b128 v[116:119], v9 offset:8192
    ds_read_b128 v[120:123], v10 offset:8192
    ds_read_b128 v[124:127], v11 offset:8192
    v_mfma_f32_32x32x16_bf16 v[144:159], v[104:107], v[212:215], v[144:159]
    v_lshl_add_u32 v5, v5, 4, v2
    v_add_u32 v5, v5, v3
    v_mfma_f32_32x32x16_bf16 v[128:143], v[108:111], v[216:219], v[128:143]
    v_mfma_f32_32x32x16_bf16 v[144:159], v[108:111], v[220:223], v[144:159]
    s_waitcnt lgkmcnt(0)
    v_mfma_f32_32x32x16_bf16 v[128:143], v[112:115], v[160:163], v[128:143]
    v_mfma_f32_32x32x16_bf16 v[144:159], v[112:115], v[164:167], v[144:159]
    v_mfma_f32_32x32x16_bf16 v[128:143], v[116:119], v[168:171], v[128:143]
    v_mfma_f32_32x32x16_bf16 v[144:159], v[116:119], v[172:175], v[144:159]
    v_mfma_f32_32x32x16_bf16 v[128:143], v[120:123], v[176:179], v[128:143]
    v_mfma_f32_32x32x16_bf16 v[144:159], v[120:123], v[180:183], v[144:159]
    v_mfma_f32_32x32x16_bf16 v[128:143], v[124:127], v[184:187], v[128:143]
    v_mfma_f32_32x32x16_bf16 v[144:159], v[124:127], v[188:191], v[144:159]
    s_cmp_eq_u32 s3, 7
    s_cbranch_scc1 L_kvnone
    s_nop 8
    v_cvt_pk_bf16_f32 v224, v128, v129
    v_cvt_pk_bf16_f32 v225, v130, v131
    v_cvt_pk_bf16_f32 v226, v132, v133
    v_cvt_pk_bf16_f32 v227, v134, v135
    buffer_store_dwordx4 v[224:227], v4, s[24:27], s22 offen offset:0 sc0 sc1
    v_cvt_pk_bf16_f32 v228, v136, v137
    v_cvt_pk_bf16_f32 v229, v138, v139
    v_cvt_pk_bf16_f32 v230, v140, v141
    v_cvt_pk_bf16_f32 v231, v142, v143
    buffer_store_dwordx4 v[228:231], v4, s[24:27], s22 offen offset:1024 sc0 sc1
    v_cvt_pk_bf16_f32 v232, v144, v145
    v_cvt_pk_bf16_f32 v233, v146, v147
    v_cvt_pk_bf16_f32 v234, v148, v149
    v_cvt_pk_bf16_f32 v235, v150, v151
    buffer_store_dwordx4 v[232:235], v5, s[24:27], s22 offen offset:0 sc0 sc1
    v_cvt_pk_bf16_f32 v236, v152, v153
    v_cvt_pk_bf16_f32 v237, v154, v155
    v_cvt_pk_bf16_f32 v238, v156, v157
    v_cvt_pk_bf16_f32 v239, v158, v159
    buffer_store_dwordx4 v[236:239], v5, s[24:27], s22 offen offset:1024 sc0 sc1
    s_cmp_eq_u32 0, 1
L_hop:
    s_cbranch_scc1 L_hopd
L_kvdone:
    s_mov_b64 exec, 1
    ds_add_u32 v250, v251
    s_mov_b64 exec, -1
    s_mov_b32 s9, 0
    s_waitcnt vmcnt(4)
    s_mov_b64 exec, 1
    ds_add_u32 v250, v251 offset:4
    s_mov_b64 exec, -1
    s_mov_b32 s64, 1048576
L_lw_5:
    ds_read_b32 v5, v250 offset:4
    s_waitcnt lgkmcnt(0)
    v_readfirstlane_b32 s66, v5
    s_cmp_ge_u32 s66, 4
    s_cbranch_scc1 L_lwd_6
    s_sub_u32 s64, s64, 1
    s_cbranch_scc0 L_lw_5
    s_mov_b32 s64, 14
    s_branch L_fail
L_lwd_6:
    s_add_u32 m0, s80, 8192
    s_mul_i32 s82, s72, 1344
    buffer_load_dwordx4 v253, s[28:31], s82 offen lds
    s_add_u32 m0, s80, 12288
    s_mul_i32 s82, s73, 1344
    buffer_load_dwordx4 v253, s[28:31], s82 offen lds
    s_add_u32 m0, s80, 16384
    s_mul_i32 s82, s74, 1344
    buffer_load_dwordx4 v253, s[28:31], s82 offen lds
    s_add_u32 m0, s80, 20480
    s_mul_i32 s82, s75, 1344
    buffer_load_dwordx4 v253, s[28:31], s82 offen lds
    s_add_u32 m0, s80, 24576
    s_mul_i32 s82, s76, 1344
    buffer_load_dwordx4 v253, s[28:31], s82 offen lds
    ds_read_b64_tr_b16 v[176:177], v15 offset:0
    ds_read_b64_tr_b16 v[178:179], v15 offset:256
    ds_read_b64_tr_b16 v[180:181], v15 offset:1024
    ds_read_b64_tr_b16 v[182:183], v15 offset:1280
    ds_read_b64_tr_b16 v[184:185], v15 offset:2048
    ds_read_b64_tr_b16 v[186:187], v15 offset:2304
    ds_read_b64_tr_b16 v[188:189], v15 offset:3072
    ds_read_b64_tr_b16 v[190:191], v15 offset:3328
    ds_read_b64_tr_b16 v[192:193], v15 offset:4096
    ds_read_b64_tr_b16 v[194:195], v15 offset:4352
    ds_read_b64_tr_b16 v[196:197], v15 offset:5120
    ds_read_b64_tr_b16 v[198:199], v15 offset:5376
    s_waitcnt lgkmcnt(10)
    v_mfma_f32_32x32x16_bf16 v[128:143], v[176:179], v[16:19], 0
    ds_read_b64_tr_b16 v[200:201], v15 offset:6144
    ds_read_b64_tr_b16 v[202:203], v15 offset:6400
    s_waitcnt lgkmcnt(10)
    v_mfma_f32_32x32x16_bf16 v[128:143], v[180:183], v[20:23], v[128:143]
    ds_read_b64_tr_b16 v[204:205], v15 offset:7168
    ds_read_b64_tr_b16 v[206:207], v15 offset:7424
    s_waitcnt lgkmcnt(10)
    v_mfma_f32_32x32x16_bf16 v[128:143], v[184:187], v[24:27], v[128:143]
    s_waitcnt lgkmcnt(8)
    v_mfma_f32_32x32x16_bf16 v[128:143], v[188:191], v[28:31], v[128:143]
    s_waitcnt lgkmcnt(6)
    v_mfma_f32_32x32x16_bf16 v[128:143], v[192:195], v[32:35], v[128:143]
    s_waitcnt lgkmcnt(4)
    v_mfma_f32_32x32x16_bf16 v[128:143], v[196:199], v[36:39], v[128:143]
    s_waitcnt lgkmcnt(2)
    v_mfma_f32_32x32x16_bf16 v[128:143], v[200:203], v[40:43], v[128:143]
    s_waitcnt lgkmcnt(0)
    v_mfma_f32_32x32x16_bf16 v[128:143], v[204:207], v[44:47], v[128:143]
    s_lshl_b32 s10, s78, 4
    s_add_u32 s10, s10, s59
    s_lshl_b32 s10, s10, 11
    s_add_u32 s10, s10, 4718592
    s_lshl_b32 s11, s60, 4
    s_add_u32 s11, s11, s59
    s_lshl_b32 s11, s11, 11
    s_add_u32 s11, s11, 262144
    v_lshlrev_b32 v246, 3, v1
    s_mov_b32 s12, 0x2b800000
    s_mov_b32 s13, 0x4e800000
    s_movk_i32 s14, 0x1f8
    s_cmp_eq_u32 s61, 0
    s_cselect_b64 s[76:77], -1, 0
    v_mov_b32 v2, v250
    v_mov_b32 v3, 1
    v_mov_b32 v7, v243
    v_mov_b32 v248, 0x3e8b97f6
    v_mov_b32 v249, v248
    s_add_u32 s66, s61, 1
    s_and_b32 s66, s66, 3
    s_lshl_b32 s67, s66, 11
    s_add_u32 s67, s67, 151552
    v_add_u32 v4, s67, v7
    s_mul_i32 s66, s66, 12288
    s_add_u32 s66, s66, 0
    v_add_u32 v10, s66, v7
    s_add_u32 s66, s61, 2
    s_and_b32 s66, s66, 3
    s_lshl_b32 s67, s66, 11
    s_add_u32 s67, s67, 151552
    v_add_u32 v6, s67, v7
    s_mul_i32 s66, s66, 12288
    s_add_u32 s66, s66, 4096
    v_add_u32 v11, s66, v7
    s_add_u32 s66, s61, 3
    s_and_b32 s66, s66, 3
    s_lshl_b32 s67, s66, 11
    s_add_u32 s67, s67, 151552
    v_add_u32 v8, s67, v7
    s_mul_i32 s66, s66, 12288
    s_add_u32 s66, s66, 8192
    v_add_u32 v12, s66, v7
    s_add_u32 s66, s61, 4
    s_and_b32 s66, s66, 3
    s_lshl_b32 s67, s66, 11
    s_add_u32 s67, s67, 151552
    v_add_u32 v9, s67, v7
    s_mul_i32 s66, s66, 12288
    s_add_u32 s66, s66, 0
    v_add_u32 v13, s66, v7
    s_waitcnt vmcnt(5)
    s_mov_b64 exec, 1
    ds_add_rtn_u32 v5, v250, v251 offset:16
    s_waitcnt lgkmcnt(0)
    v_readfirstlane_b32 s66, v5
    s_cmp_eq_u32 s66, 3
    s_cselect_b64 exec, -1, 0
    buffer_store_dwordx2 v[244:245], v247, s[24:27], s8 offen sc1
    s_mov_b64 exec, -1
    s_waitcnt vmcnt(1)
    s_mov_b64 exec, 1
    ds_add_u32 v250, v251 offset:4
    s_mov_b64 exec, -1
    s_mov_b32 s64, 1048576
L_lw_8:
    ds_read_b32 v5, v250 offset:4
    s_waitcnt lgkmcnt(0)
    v_readfirstlane_b32 s66, v5
    s_cmp_ge_u32 s66, 8
    s_cbranch_scc1 L_lwd_9
    s_sub_u32 s64, s64, 1
    s_cbranch_scc0 L_lw_8
    s_mov_b32 s64, 14
    s_branch L_fail
L_lwd_9:
    ds_read_b64_tr_b16 v[208:209], v15 offset:8192
    ds_read_b64_tr_b16 v[210:211], v15 offset:8448
    ds_read_b64_tr_b16 v[212:213], v15 offset:9216
    ds_read_b64_tr_b16 v[214:215], v15 offset:9472
    ds_read_b64_tr_b16 v[216:217], v15 offset:10240
    ds_read_b64_tr_b16 v[218:219], v15 offset:10496
    ds_read_b64_tr_b16 v[220:221], v15 offset:11264
    ds_read_b64_tr_b16 v[222:223], v15 offset:11520
    ds_read_b64_tr_b16 v[176:177], v15 offset:12288
    ds_read_b64_tr_b16 v[178:179], v15 offset:12544
    ds_read_b64_tr_b16 v[180:181], v15 offset:13312
    ds_read_b64_tr_b16 v[182:183], v15 offset:13568
    s_waitcnt lgkmcnt(10)
    v_mfma_f32_32x32x16_bf16 v[128:143], v[208:211], v[48:51], v[128:143]
    ds_read_b64_tr_b16 v[184:185], v15 offset:14336
    ds_read_b64_tr_b16 v[186:187], v15 offset:14592
    s_waitcnt lgkmcnt(10)
    v_mfma_f32_32x32x16_bf16 v[128:143], v[212:215], v[52:55], v[128:143]
    ds_read_b64_tr_b16 v[188:189], v15 offset:15360
    ds_read_b64_tr_b16 v[190:191], v15 offset:15616
    s_waitcnt lgkmcnt(10)
    v_mfma_f32_32x32x16_bf16 v[128:143], v[216:219], v[56:59], v[128:143]
    ds_read_b64_tr_b16 v[192:193], v15 offset:16384
    ds_read_b64_tr_b16 v[194:195], v15 offset:16640
    s_waitcnt lgkmcnt(10)
    v_mfma_f32_32x32x16_bf16 v[128:143], v[220:223], v[60:63], v[128:143]
    ds_read_b64_tr_b16 v[196:197], v15 offset:17408
    ds_read_b64_tr_b16 v[198:199], v15 offset:17664
    s_waitcnt lgkmcnt(10)
    v_mfma_f32_32x32x16_bf16 v[128:143], v[176:179], v[64:67], v[128:143]
    ds_read_b64_tr_b16 v[200:201], v15 offset:18432
    ds_read_b64_tr_b16 v[202:203], v15 offset:18688
    s_waitcnt lgkmcnt(10)
    v_mfma_f32_32x32x16_bf16 v[128:143], v[180:183], v[68:71], v[128:143]
    ds_read_b64_tr_b16 v[204:205], v15 offset:19456
    ds_read_b64_tr_b16 v[206:207], v15 offset:19712
    s_waitcnt lgkmcnt(10)
    v_mfma_f32_32x32x16_bf16 v[128:143], v[184:187], v[72:75], v[128:143]
    ds_read_b64_tr_b16 v[208:209], v15 offset:20480
    ds_read_b64_tr_b16 v[210:211], v15 offset:20736
    v_mov_b32 v254, 0
    v_mov_b32 v255, 0
    s_mov_b64 exec, s[0:1]
    buffer_atomic_or_x2 v[254:255], v242, s[24:27], s4 offen sc0 sc1
    s_mov_b64 exec, -1
    s_waitcnt lgkmcnt(10)
    v_mfma_f32_32x32x16_bf16 v[128:143], v[188:191], v[76:79], v[128:143]
    ds_read_b64_tr_b16 v[212:213], v15 offset:21504
    ds_read_b64_tr_b16 v[214:215], v15 offset:21760
    s_waitcnt lgkmcnt(10)
    v_mfma_f32_32x32x16_bf16 v[128:143], v[192:195], v[80:83], v[128:143]
    ds_read_b64_tr_b16 v[216:217], v15 offset:22528
    ds_read_b64_tr_b16 v[218:219], v15 offset:22784
    s_waitcnt lgkmcnt(10)
    v_mfma_f32_32x32x16_bf16 v[128:143], v[196:199], v[84:87], v[128:143]
    ds_read_b64_tr_b16 v[220:221], v15 offset:23552
    ds_read_b64_tr_b16 v[222:223], v15 offset:23808
    s_waitcnt lgkmcnt(10)
    v_mfma_f32_32x32x16_bf16 v[128:143], v[200:203], v[88:91], v[128:143]
    ds_read_b64_tr_b16 v[176:177], v15 offset:24576
    ds_read_b64_tr_b16 v[178:179], v15 offset:24832
    s_waitcnt lgkmcnt(10)
    v_mfma_f32_32x32x16_bf16 v[128:143], v[204:207], v[92:95], v[128:143]
    ds_read_b64_tr_b16 v[180:181], v15 offset:25600
    ds_read_b64_tr_b16 v[182:183], v15 offset:25856
    s_waitcnt lgkmcnt(10)
    v_mfma_f32_32x32x16_bf16 v[128:143], v[208:211], v[96:99], v[128:143]
    ds_read_b64_tr_b16 v[184:185], v15 offset:26624
    ds_read_b64_tr_b16 v[186:187], v15 offset:26880
    s_waitcnt lgkmcnt(10)
    v_mfma_f32_32x32x16_bf16 v[128:143], v[212:215], v[100:103], v[128:143]
    ds_read_b64_tr_b16 v[188:189], v15 offset:27648
    ds_read_b64_tr_b16 v[190:191], v15 offset:27904
    s_waitcnt lgkmcnt(10)
    v_mfma_f32_32x32x16_bf16 v[128:143], v[216:219], v[104:107], v[128:143]
    s_waitcnt lgkmcnt(8)
    v_mfma_f32_32x32x16_bf16 v[128:143], v[220:223], v[108:111], v[128:143]
    s_waitcnt lgkmcnt(6)
    v_mfma_f32_32x32x16_bf16 v[128:143], v[176:179], v[112:115], v[128:143]
    s_waitcnt lgkmcnt(4)
    v_mfma_f32_32x32x16_bf16 v[128:143], v[180:183], v[116:119], v[128:143]
    s_waitcnt lgkmcnt(2)
    v_mfma_f32_32x32x16_bf16 v[128:143], v[184:187], v[120:123], v[128:143]
    s_waitcnt lgkmcnt(0)
    v_mfma_f32_32x32x16_bf16 v[128:143], v[188:191], v[124:127], v[128:143]
L_qdone:
    s_bitcmp1_b32 s59, 0
    s_nop 10
    v_mul_f32 v128, v128, v248
    v_mul_f32 v129, v129, v249
    v_mul_f32 v130, v130, v248
    v_mul_f32 v131, v131, v249
    v_mul_f32 v132, v132, v248
    v_mul_f32 v133, v133, v249
    v_mul_f32 v134, v134, v248
    v_mul_f32 v135, v135, v249
    v_cvt_pk_bf16_f32 v224, v128, v129
    v_cvt_pk_bf16_f32 v225, v130, v131
    v_cvt_pk_bf16_f32 v226, v132, v133
    v_cvt_pk_bf16_f32 v227, v134, v135
    s_cselect_b32 exec_lo, -1, 0
    s_mov_b32 exec_hi, 0
    v_mov_b32 v224, 0
    v_mov_b32 v225, 0
    s_mov_b64 exec, -1
    ds_write_b128 v9, v[224:227] offset:0
    v_mul_f32 v136, v136, v248
    v_mul_f32 v137, v137, v249
    v_mul_f32 v138, v138, v248
    v_mul_f32 v139, v139, v249
    v_mul_f32 v140, v140, v248
    v_mul_f32 v141, v141, v249
    v_mul_f32 v142, v142, v248
    v_mul_f32 v143, v143, v249
    v_cvt_pk_bf16_f32 v228, v136, v137
    v_cvt_pk_bf16_f32 v229, v138, v139
    v_cvt_pk_bf16_f32 v230, v140, v141
    v_cvt_pk_bf16_f32 v231, v142, v143
    s_cselect_b32 exec_hi, 0, -1
    s_mov_b32 exec_lo, 0
    v_mov_b32 v230, 0
    v_mov_b32 v231, 0
    s_mov_b64 exec, -1
    ds_write_b128 v9, v[228:231] offset:1024
    s_mov_b64 exec, 1
    ds_add_u32 v2, v3
    s_mov_b64 exec, -1
    s_cmp_eq_u32 s9, 1
    s_cbranch_scc1 L_kvloaded
    s_waitcnt vmcnt(0)
    v_cmp_ne_u64 vcc, s[62:63], v[254:255]
    s_and_b64 vcc, vcc, s[0:1]
    s_cbranch_scc0 L_kvready
    s_mov_b32 s64, 131072
L_poll_10:
    v_mov_b32 v254, 0
    v_mov_b32 v255, 0
    s_mov_b64 exec, s[0:1]
    buffer_atomic_or_x2 v[254:255], v242, s[24:27], s4 offen sc0 sc1
    s_mov_b64 exec, -1
    s_waitcnt vmcnt(0)
    v_cmp_ne_u64 vcc, s[62:63], v[254:255]
    s_and_b64 vcc, vcc, s[0:1]
    s_cbranch_scc0 L_polld_11
    s_sleep 2
    s_sub_u32 s64, s64, 1
    s_cbranch_scc0 L_poll_10
    s_mov_b32 s64, 1
    s_branch L_fail
L_polld_11:
L_kvready:
    buffer_load_dwordx4 v[144:147], v240, s[24:27], s36 offen offset:0 sc1
    buffer_load_dwordx4 v[148:151], v240, s[24:27], s36 offen offset:1024 sc1
    buffer_load_dwordx4 v[152:155], v241, s[24:27], s36 offen offset:0 sc1
    buffer_load_dwordx4 v[156:159], v241, s[24:27], s36 offen offset:1024 sc1
    buffer_load_dwordx4 v[160:163], v240, s[24:27], s37 offen offset:0 sc1
    buffer_load_dwordx4 v[164:167], v240, s[24:27], s37 offen offset:1024 sc1
    buffer_load_dwordx4 v[168:171], v241, s[24:27], s37 offen offset:0 sc1
    buffer_load_dwordx4 v[172:175], v241, s[24:27], s37 offen offset:1024 sc1
L_kvloaded:
    s_mov_b64 exec, 1
    ds_add_u32 v2, v3 offset:12
    s_mov_b64 exec, -1
    s_mov_b32 s64, 1048576
L_lw_12:
    ds_read_b32 v5, v2 offset:0
    s_waitcnt lgkmcnt(0)
    v_readfirstlane_b32 s66, v5
    s_cmp_ge_u32 s66, 12
    s_cbranch_scc1 L_lwd_13
    s_sub_u32 s64, s64, 1
    s_cbranch_scc0 L_lw_12
    s_mov_b32 s64, 15
    s_branch L_fail
L_lwd_13:
    s_mov_b32 s65, 12
    ds_read_b128 v[16:19], v4
    ds_read_b128 v[20:23], v4 offset:1024
    ds_read_b128 v[24:27], v6
    ds_read_b128 v[28:31], v6 offset:1024
    ds_read_b128 v[32:35], v8
    ds_read_b128 v[36:39], v8 offset:1024
    ds_read_b128 v[40:43], v9
    ds_read_b128 v[44:47], v9 offset:1024
    s_waitcnt vmcnt(6) lgkmcnt(6)
    s_setprio 0
    v_mfma_f32_32x32x16_bf16 v[112:127], v[144:147], v[16:19], 0
    v_mfma_f32_32x32x16_bf16 v[112:127], v[148:151], v[20:23], v[112:127]
    s_waitcnt vmcnt(4) lgkmcnt(0)
    s_nop 9
.p2align 3
    v_mfma_f32_32x32x16_bf16 v[128:143], v[144:147], v[24:27], 0
    buffer_load_dwordx2 v[14:15], v242, s[24:27], s5 offen sc1
    v_exp_f32 v112, v112
    v_exp_f32 v113, v113
    v_exp_f32 v114, v114
    v_exp_f32 v115, v115
    v_cvt_pk_bf16_f32 v224, v112, v113
    v_cvt_pk_bf16_f32 v225, v114, v115
    v_mfma_f32_32x32x16_bf16 v[128:143], v[148:151], v[28:31], v[128:143]
    v_exp_f32 v116, v116
    v_exp_f32 v117, v117
    v_exp_f32 v118, v118
    v_exp_f32 v119, v119
    v_cvt_pk_bf16_f32 v226, v116, v117
    v_cvt_pk_bf16_f32 v227, v118, v119
    v_exp_f32 v120, v120
    v_exp_f32 v121, v121
    v_exp_f32 v122, v122
    v_exp_f32 v123, v123
    v_cvt_pk_bf16_f32 v228, v120, v121
    v_cvt_pk_bf16_f32 v229, v122, v123
    v_mfma_f32_32x32x16_bf16 v[48:63], v[152:155], v[224:227], 0
    v_exp_f32 v124, v124
    v_exp_f32 v125, v125
    v_exp_f32 v126, v126
    v_exp_f32 v127, v127
    v_cvt_pk_bf16_f32 v230, v124, v125
    v_cvt_pk_bf16_f32 v231, v126, v127
    v_mfma_f32_32x32x16_bf16 v[112:127], v[144:147], v[32:35], 0
    buffer_load_dwordx4 v[176:179], v240, s[24:27], s38 offen offset:0 sc1
    v_exp_f32 v128, v128
    v_exp_f32 v129, v129
    v_exp_f32 v130, v130
    v_exp_f32 v131, v131
    v_cvt_pk_bf16_f32 v224, v128, v129
    v_cvt_pk_bf16_f32 v225, v130, v131
    v_mfma_f32_32x32x16_bf16 v[112:127], v[148:151], v[36:39], v[112:127]
    buffer_load_dwordx4 v[180:183], v240, s[24:27], s38 offen offset:1024 sc1
    v_exp_f32 v132, v132
    v_exp_f32 v133, v133
    v_exp_f32 v134, v134
    v_exp_f32 v135, v135
    v_cvt_pk_bf16_f32 v226, v132, v133
    v_cvt_pk_bf16_f32 v227, v134, v135
    v_mfma_f32_32x32x16_bf16 v[48:63], v[156:159], v[228:231], v[48:63]
    buffer_load_dwordx4 v[184:187], v241, s[24:27], s38 offen offset:0 sc1
    v_exp_f32 v136, v136
    v_exp_f32 v137, v137
    v_exp_f32 v138, v138
    v_exp_f32 v139, v139
    v_cvt_pk_bf16_f32 v228, v136, v137
    v_cvt_pk_bf16_f32 v229, v138, v139
    v_mfma_f32_32x32x16_bf16 v[64:79], v[152:155], v[224:227], 0
    buffer_load_dwordx4 v[188:191], v241, s[24:27], s38 offen offset:1024 sc1
    v_exp_f32 v140, v140
    v_exp_f32 v141, v141
    v_exp_f32 v142, v142
    v_exp_f32 v143, v143
    v_cvt_pk_bf16_f32 v230, v140, v141
    v_cvt_pk_bf16_f32 v231, v142, v143
    v_mfma_f32_32x32x16_bf16 v[128:143], v[144:147], v[40:43], 0
    buffer_load_dwordx4 v[192:195], v240, s[24:27], s39 offen offset:0 sc1
    v_exp_f32 v112, v112
    v_exp_f32 v113, v113
    v_exp_f32 v114, v114
    v_exp_f32 v115, v115
    v_cvt_pk_bf16_f32 v224, v112, v113
    v_cvt_pk_bf16_f32 v225, v114, v115
    v_mfma_f32_32x32x16_bf16 v[128:143], v[148:151], v[44:47], v[128:143]
    buffer_load_dwordx4 v[196:199], v240, s[24:27], s39 offen offset:1024 sc1
    v_exp_f32 v116, v116
    v_exp_f32 v117, v117
    v_exp_f32 v118, v118
    v_exp_f32 v119, v119
    v_cvt_pk_bf16_f32 v226, v116, v117
    v_cvt_pk_bf16_f32 v227, v118, v119
    v_mfma_f32_32x32x16_bf16 v[64:79], v[156:159], v[228:231], v[64:79]
    buffer_load_dwordx4 v[200:203], v241, s[24:27], s39 offen offset:0 sc1
    v_exp_f32 v120, v120
    v_exp_f32 v121, v121
    v_exp_f32 v122, v122
    v_exp_f32 v123, v123
    v_cvt_pk_bf16_f32 v228, v120, v121
    v_cvt_pk_bf16_f32 v229, v122, v123
    v_mfma_f32_32x32x16_bf16 v[80:95], v[152:155], v[224:227], 0
    buffer_load_dwordx4 v[204:207], v241, s[24:27], s39 offen offset:1024 sc1
    v_exp_f32 v124, v124
    v_exp_f32 v125, v125
    v_exp_f32 v126, v126
    s_waitcnt vmcnt(9)
    v_exp_f32_e64 v127, v127
    v_cvt_pk_bf16_f32 v230, v124, v125
    v_cvt_pk_bf16_f32 v231, v126, v127
    v_mfma_f32_32x32x16_bf16 v[112:127], v[160:163], v[16:19], 0
    v_exp_f32 v128, v128
    v_exp_f32 v129, v129
    v_exp_f32 v130, v130
    v_exp_f32 v131, v131
    v_cvt_pk_bf16_f32 v224, v128, v129
    v_cvt_pk_bf16_f32 v225, v130, v131
    v_mfma_f32_32x32x16_bf16 v[112:127], v[164:167], v[20:23], v[112:127]
    v_exp_f32 v132, v132
    v_exp_f32 v133, v133
    v_exp_f32 v134, v134
    v_exp_f32 v135, v135
    v_cvt_pk_bf16_f32 v226, v132, v133
    v_cvt_pk_bf16_f32 v227, v134, v135
    v_mfma_f32_32x32x16_bf16 v[80:95], v[156:159], v[228:231], v[80:95]
    v_exp_f32 v136, v136
    v_exp_f32 v137, v137
    v_exp_f32 v138, v138
    v_exp_f32 v139, v139
    v_cvt_pk_bf16_f32 v228, v136, v137
    v_cvt_pk_bf16_f32 v229, v138, v139
    v_mfma_f32_32x32x16_bf16 v[96:111], v[152:155], v[224:227], 0
    v_exp_f32 v140, v140
    v_exp_f32 v141, v141
    v_exp_f32 v142, v142
    v_exp_f32 v143, v143
    v_cvt_pk_bf16_f32 v230, v140, v141
    v_cvt_pk_bf16_f32 v231, v142, v143
    v_mfma_f32_32x32x16_bf16 v[128:143], v[160:163], v[24:27], 0
    v_exp_f32 v112, v112
    v_exp_f32 v113, v113
    v_exp_f32 v114, v114
    v_exp_f32 v115, v115
    v_cvt_pk_bf16_f32 v224, v112, v113
    v_cvt_pk_bf16_f32 v225, v114, v115
    v_mfma_f32_32x32x16_bf16 v[128:143], v[164:167], v[28:31], v[128:143]
    v_exp_f32 v116, v116
    v_exp_f32 v117, v117
    v_exp_f32 v118, v118
    v_exp_f32 v119, v119
    v_cvt_pk_bf16_f32 v226, v116, v117
    v_cvt_pk_bf16_f32 v227, v118, v119
    v_mfma_f32_32x32x16_bf16 v[96:111], v[156:159], v[228:231], v[96:111]
    v_exp_f32 v120, v120
    v_exp_f32 v121, v121
    v_exp_f32 v122, v122
    v_exp_f32 v123, v123
    v_cvt_pk_bf16_f32 v228, v120, v121
    v_cvt_pk_bf16_f32 v229, v122, v123
    v_mfma_f32_32x32x16_bf16 v[48:63], v[168:171], v[224:227], v[48:63]
    v_exp_f32 v124, v124
    v_exp_f32 v125, v125
    v_exp_f32 v126, v126
    v_exp_f32 v127, v127
    v_cvt_pk_bf16_f32 v230, v124, v125
    v_cvt_pk_bf16_f32 v231, v126, v127
    s_waitcnt vmcnt(8)
    v_cmp_ne_u64 vcc, s[62:63], v[14:15]
    s_cbranch_vccnz L_gate1
L_gated1:
    s_nop 0
    v_mfma_f32_32x32x16_bf16 v[112:127], v[160:163], v[32:35], 0
    buffer_load_dwordx4 v[208:211], v240, s[24:27], s40 offen offset:0 sc1
    v_exp_f32 v128, v128
    v_exp_f32 v129, v129
    v_exp_f32 v130, v130
    v_exp_f32 v131, v131
    v_cvt_pk_bf16_f32 v224, v128, v129
    v_cvt_pk_bf16_f32 v225, v130, v131
    v_mfma_f32_32x32x16_bf16 v[112:127], v[164:167], v[36:39], v[112:127]
    buffer_load_dwordx4 v[212:215], v240, s[24:27], s40 offen offset:1024 sc1
    v_exp_f32 v132, v132
    v_exp_f32 v133, v133
    v_exp_f32 v134, v134
    v_exp_f32 v135, v135
    v_cvt_pk_bf16_f32 v226, v132, v133
    v_cvt_pk_bf16_f32 v227, v134, v135
    v_mfma_f32_32x32x16_bf16 v[48:63], v[172:175], v[228:231], v[48:63]
    buffer_load_dwordx4 v[216:219], v241, s[24:27], s40 offen offset:0 sc1
    v_exp_f32 v136, v136
    v_exp_f32 v137, v137
    v_exp_f32 v138, v138
    v_exp_f32 v139, v139
    v_cvt_pk_bf16_f32 v228, v136, v137
    v_cvt_pk_bf16_f32 v229, v138, v139
    v_mfma_f32_32x32x16_bf16 v[64:79], v[168:171], v[224:227], v[64:79]
    buffer_load_dwordx4 v[220:223], v241, s[24:27], s40 offen offset:1024 sc1
    v_exp_f32 v140, v140
    v_exp_f32 v141, v141
    v_exp_f32 v142, v142
    v_exp_f32 v143, v143
    v_cvt_pk_bf16_f32 v230, v140, v141
    v_cvt_pk_bf16_f32 v231, v142, v143
    v_mfma_f32_32x32x16_bf16 v[128:143], v[160:163], v[40:43], 0
    buffer_load_dwordx4 v[144:147], v240, s[24:27], s41 offen offset:0 sc1
    v_exp_f32 v112, v112
    v_exp_f32 v113, v113
    v_exp_f32 v114, v114
    v_exp_f32 v115, v115
    v_cvt_pk_bf16_f32 v224, v112, v113
    v_cvt_pk_bf16_f32 v225, v114, v115
    v_mfma_f32_32x32x16_bf16 v[128:143], v[164:167], v[44:47], v[128:143]
    buffer_load_dwordx4 v[148:151], v240, s[24:27], s41 offen offset:1024 sc1
    v_exp_f32 v116, v116
    v_exp_f32 v117, v117
    v_exp_f32 v118, v118
    v_exp_f32 v119, v119
    v_cvt_pk_bf16_f32 v226, v116, v117
    v_cvt_pk_bf16_f32 v227, v118, v119
    v_mfma_f32_32x32x16_bf16 v[64:79], v[172:175], v[228:231], v[64:79]
    buffer_load_dwordx4 v[152:155], v241, s[24:27], s41 offen offset:0 sc1
    v_exp_f32 v120, v120
    v_exp_f32 v121, v121
    v_exp_f32 v122, v122
    v_exp_f32 v123, v123
    v_cvt_pk_bf16_f32 v228, v120, v121
    v_cvt_pk_bf16_f32 v229, v122, v123
    v_mfma_f32_32x32x16_bf16 v[80:95], v[168:171], v[224:227], v[80:95]
    buffer_load_dwordx4 v[156:159], v241, s[24:27], s41 offen offset:1024 sc1
    v_exp_f32 v124, v124
    v_exp_f32 v125, v125
    v_exp_f32 v126, v126
    s_waitcnt vmcnt(12)
    v_exp_f32_e64 v127, v127
    v_cvt_pk_bf16_f32 v230, v124, v125
    v_cvt_pk_bf16_f32 v231, v126, v127
    v_mfma_f32_32x32x16_bf16 v[112:127], v[176:179], v[16:19], 0
    v_exp_f32 v128, v128
    v_exp_f32 v129, v129
    v_exp_f32 v130, v130
    v_exp_f32 v131, v131
    v_cvt_pk_bf16_f32 v224, v128, v129
    v_cvt_pk_bf16_f32 v225, v130, v131
    v_mfma_f32_32x32x16_bf16 v[112:127], v[180:183], v[20:23], v[112:127]
    v_exp_f32 v132, v132
    v_exp_f32 v133, v133
    v_exp_f32 v134, v134
    v_exp_f32 v135, v135
    v_cvt_pk_bf16_f32 v226, v132, v133
    v_cvt_pk_bf16_f32 v227, v134, v135
    v_mfma_f32_32x32x16_bf16 v[80:95], v[172:175], v[228:231], v[80:95]
    v_exp_f32 v136, v136
    v_exp_f32 v137, v137
    v_exp_f32 v138, v138
    v_exp_f32 v139, v139
    v_cvt_pk_bf16_f32 v228, v136, v137
    v_cvt_pk_bf16_f32 v229, v138, v139
    v_mfma_f32_32x32x16_bf16 v[96:111], v[168:171], v[224:227], v[96:111]
    v_exp_f32 v140, v140
    v_exp_f32 v141, v141
    v_exp_f32 v142, v142
    v_exp_f32 v143, v143
    v_cvt_pk_bf16_f32 v230, v140, v141
    v_cvt_pk_bf16_f32 v231, v142, v143
    v_mfma_f32_32x32x16_bf16 v[128:143], v[176:179], v[24:27], 0
    v_exp_f32 v112, v112
    v_exp_f32 v113, v113
    v_exp_f32 v114, v114
    v_exp_f32 v115, v115
    v_cvt_pk_bf16_f32 v224, v112, v113
    v_cvt_pk_bf16_f32 v225, v114, v115
    v_mfma_f32_32x32x16_bf16 v[128:143], v[180:183], v[28:31], v[128:143]
    v_exp_f32 v116, v116
    v_exp_f32 v117, v117
    v_exp_f32 v118, v118
    v_exp_f32 v119, v119
    v_cvt_pk_bf16_f32 v226, v116, v117
    v_cvt_pk_bf16_f32 v227, v118, v119
    v_mfma_f32_32x32x16_bf16 v[96:111], v[172:175], v[228:231], v[96:111]
    v_exp_f32 v120, v120
    v_exp_f32 v121, v121
    v_exp_f32 v122, v122
    v_exp_f32 v123, v123
    v_cvt_pk_bf16_f32 v228, v120, v121
    v_cvt_pk_bf16_f32 v229, v122, v123
    v_mfma_f32_32x32x16_bf16 v[48:63], v[184:187], v[224:227], v[48:63]
    v_exp_f32 v124, v124
    v_exp_f32 v125, v125
    v_exp_f32 v126, v126
    v_exp_f32 v127, v127
    v_cvt_pk_bf16_f32 v230, v124, v125
    v_cvt_pk_bf16_f32 v231, v126, v127
    v_mfma_f32_32x32x16_bf16 v[112:127], v[176:179], v[32:35], 0
    buffer_load_dwordx4 v[160:163], v240, s[24:27], s42 offen offset:0 sc1
    v_exp_f32 v128, v128
    v_exp_f32 v129, v129
    v_exp_f32 v130, v130
    v_exp_f32 v131, v131
    v_cvt_pk_bf16_f32 v224, v128, v129
    v_cvt_pk_bf16_f32 v225, v130, v131
    v_mfma_f32_32x32x16_bf16 v[112:127], v[180:183], v[36:39], v[112:127]
    buffer_load_dwordx4 v[164:167], v240, s[24:27], s42 offen offset:1024 sc1
    v_exp_f32 v132, v132
    v_exp_f32 v133, v133
    v_exp_f32 v134, v134
    v_exp_f32 v135, v135
    v_cvt_pk_bf16_f32 v226, v132, v133
    v_cvt_pk_bf16_f32 v227, v134, v135
    v_mfma_f32_32x32x16_bf16 v[48:63], v[188:191], v[228:231], v[48:63]
    buffer_load_dwordx4 v[168:171], v241, s[24:27], s42 offen offset:0 sc1
    v_exp_f32 v136, v136
    v_exp_f32 v137, v137
    v_exp_f32 v138, v138
    v_exp_f32 v139, v139
    v_cvt_pk_bf16_f32 v228, v136, v137
    v_cvt_pk_bf16_f32 v229, v138, v139
    v_mfma_f32_32x32x16_bf16 v[64:79], v[184:187], v[224:227], v[64:79]
    buffer_load_dwordx4 v[172:175], v241, s[24:27], s42 offen offset:1024 sc1
    v_exp_f32 v140, v140
    v_exp_f32 v141, v141
    v_exp_f32 v142, v142
    v_exp_f32 v143, v143
    v_cvt_pk_bf16_f32 v230, v140, v141
    v_cvt_pk_bf16_f32 v231, v142, v143
    v_mfma_f32_32x32x16_bf16 v[128:143], v[176:179], v[40:43], 0
    v_exp_f32 v112, v112
    v_exp_f32 v113, v113
    v_exp_f32 v114, v114
    v_exp_f32 v115, v115
    v_cvt_pk_bf16_f32 v224, v112, v113
    v_cvt_pk_bf16_f32 v225, v114, v115
    v_mfma_f32_32x32x16_bf16 v[128:143], v[180:183], v[44:47], v[128:143]
    v_exp_f32 v116, v116
    v_exp_f32 v117, v117
    v_exp_f32 v118, v118
    v_exp_f32 v119, v119
    v_cvt_pk_bf16_f32 v226, v116, v117
    v_cvt_pk_bf16_f32 v227, v118, v119
    v_mfma_f32_32x32x16_bf16 v[64:79], v[188:191], v[228:231], v[64:79]
    v_exp_f32 v120, v120
    v_exp_f32 v121, v121
    v_exp_f32 v122, v122
    v_exp_f32 v123, v123
    v_cvt_pk_bf16_f32 v228, v120, v121
    v_cvt_pk_bf16_f32 v229, v122, v123
    v_mfma_f32_32x32x16_bf16 v[80:95], v[184:187], v[224:227], v[80:95]
    v_exp_f32 v124, v124
    v_exp_f32 v125, v125
    v_exp_f32 v126, v126
    s_waitcnt vmcnt(12)
    v_exp_f32_e64 v127, v127
    v_cvt_pk_bf16_f32 v230, v124, v125
    v_cvt_pk_bf16_f32 v231, v126, v127
    v_mfma_f32_32x32x16_bf16 v[112:127], v[192:195], v[16:19], 0
    v_exp_f32 v128, v128
    v_exp_f32 v129, v129
    v_exp_f32 v130, v130
    v_exp_f32 v131, v131
    v_cvt_pk_bf16_f32 v224, v128, v129
    v_cvt_pk_bf16_f32 v225, v130, v131
    v_mfma_f32_32x32x16_bf16 v[112:127], v[196:199], v[20:23], v[112:127]
    v_exp_f32 v132, v132
    v_exp_f32 v133, v133
    v_exp_f32 v134, v134
    v_exp_f32 v135, v135
    v_cvt_pk_bf16_f32 v226, v132, v133
    v_cvt_pk_bf16_f32 v227, v134, v135
    v_mfma_f32_32x32x16_bf16 v[80:95], v[188:191], v[228:231], v[80:95]
    v_exp_f32 v136, v136
    v_exp_f32 v137, v137
    v_exp_f32 v138, v138
    v_exp_f32 v139, v139
    v_cvt_pk_bf16_f32 v228, v136, v137
    v_cvt_pk_bf16_f32 v229, v138, v139
    v_mfma_f32_32x32x16_bf16 v[96:111], v[184:187], v[224:227], v[96:111]
    v_exp_f32 v140, v140
    v_exp_f32 v141, v141
    v_exp_f32 v142, v142
    v_exp_f32 v143, v143
    v_cvt_pk_bf16_f32 v230, v140, v141
    v_cvt_pk_bf16_f32 v231, v142, v143
    v_mfma_f32_32x32x16_bf16 v[128:143], v[192:195], v[24:27], 0
    buffer_load_dwordx2 v[14:15], v242, s[24:27], s6 offen sc1
    v_exp_f32 v112, v112
    v_exp_f32 v113, v113
    v_exp_f32 v114, v114
    v_exp_f32 v115, v115
    v_cvt_pk_bf16_f32 v224, v112, v113
    v_cvt_pk_bf16_f32 v225, v114, v115
    v_mfma_f32_32x32x16_bf16 v[128:143], v[196:199], v[28:31], v[128:143]
    v_exp_f32 v116, v116
    v_exp_f32 v117, v117
    v_exp_f32 v118, v118
    v_exp_f32 v119, v119
    v_cvt_pk_bf16_f32 v226, v116, v117
    v_cvt_pk_bf16_f32 v227, v118, v119
    v_mfma_f32_32x32x16_bf16 v[96:111], v[188:191], v[228:231], v[96:111]
    v_exp_f32 v120, v120
    v_exp_f32 v121, v121
    v_exp_f32 v122, v122
    v_exp_f32 v123, v123
    v_cvt_pk_bf16_f32 v228, v120, v121
    v_cvt_pk_bf16_f32 v229, v122, v123
    v_mfma_f32_32x32x16_bf16 v[48:63], v[200:203], v[224:227], v[48:63]
    v_exp_f32 v124, v124
    v_exp_f32 v125, v125
    v_exp_f32 v126, v126
    v_exp_f32 v127, v127
    v_cvt_pk_bf16_f32 v230, v124, v125
    v_cvt_pk_bf16_f32 v231, v126, v127
    v_mfma_f32_32x32x16_bf16 v[112:127], v[192:195], v[32:35], 0
    buffer_load_dwordx4 v[176:179], v240, s[24:27], s43 offen offset:0 sc1
    v_exp_f32 v128, v128
    v_exp_f32 v129, v129
    v_exp_f32 v130, v130
    v_exp_f32 v131, v131
    v_cvt_pk_bf16_f32 v224, v128, v129
    v_cvt_pk_bf16_f32 v225, v130, v131
    v_mfma_f32_32x32x16_bf16 v[112:127], v[196:199], v[36:39], v[112:127]
    buffer_load_dwordx4 v[180:183], v240, s[24:27], s43 offen offset:1024 sc1
    v_exp_f32 v132, v132
    v_exp_f32 v133, v133
    v_exp_f32 v134, v134
    v_exp_f32 v135, v135
    v_cvt_pk_bf16_f32 v226, v132, v133
    v_cvt_pk_bf16_f32 v227, v134, v135
    v_mfma_f32_32x32x16_bf16 v[48:63], v[204:207], v[228:231], v[48:63]
    buffer_load_dwordx4 v[184:187], v241, s[24:27], s43 offen offset:0 sc1
    v_exp_f32 v136, v136
    v_exp_f32 v137, v137
    v_exp_f32 v138, v138
    v_exp_f32 v139, v139
    v_cvt_pk_bf16_f32 v228, v136, v137
    v_cvt_pk_bf16_f32 v229, v138, v139
    v_mfma_f32_32x32x16_bf16 v[64:79], v[200:203], v[224:227], v[64:79]
    buffer_load_dwordx4 v[188:191], v241, s[24:27], s43 offen offset:1024 sc1
    v_exp_f32 v140, v140
    v_exp_f32 v141, v141
    v_exp_f32 v142, v142
    v_exp_f32 v143, v143
    v_cvt_pk_bf16_f32 v230, v140, v141
    v_cvt_pk_bf16_f32 v231, v142, v143
    v_mfma_f32_32x32x16_bf16 v[128:143], v[192:195], v[40:43], 0
    v_exp_f32 v112, v112
    v_exp_f32 v113, v113
    v_exp_f32 v114, v114
    v_exp_f32 v115, v115
    v_cvt_pk_bf16_f32 v224, v112, v113
    v_cvt_pk_bf16_f32 v225, v114, v115
    v_mfma_f32_32x32x16_bf16 v[128:143], v[196:199], v[44:47], v[128:143]
    v_exp_f32 v116, v116
    v_exp_f32 v117, v117
    v_exp_f32 v118, v118
    v_exp_f32 v119, v119
    v_cvt_pk_bf16_f32 v226, v116, v117
    v_cvt_pk_bf16_f32 v227, v118, v119
    v_mfma_f32_32x32x16_bf16 v[64:79], v[204:207], v[228:231], v[64:79]
    v_exp_f32 v120, v120
    v_exp_f32 v121, v121
    v_exp_f32 v122, v122
    v_exp_f32 v123, v123
    v_cvt_pk_bf16_f32 v228, v120, v121
    v_cvt_pk_bf16_f32 v229, v122, v123
    v_mfma_f32_32x32x16_bf16 v[80:95], v[200:203], v[224:227], v[80:95]
    v_exp_f32 v124, v124
    v_exp_f32 v125, v125
    v_exp_f32 v126, v126
    s_waitcnt vmcnt(13)
    v_exp_f32_e64 v127, v127
    v_cvt_pk_bf16_f32 v230, v124, v125
    v_cvt_pk_bf16_f32 v231, v126, v127
    v_mfma_f32_32x32x16_bf16 v[112:127], v[208:211], v[16:19], 0
    v_exp_f32 v128, v128
    v_exp_f32 v129, v129
    v_exp_f32 v130, v130
    v_exp_f32 v131, v131
    v_cvt_pk_bf16_f32 v224, v128, v129
    v_cvt_pk_bf16_f32 v225, v130, v131
    v_mfma_f32_32x32x16_bf16 v[112:127], v[212:215], v[20:23], v[112:127]
    v_exp_f32 v132, v132
    v_exp_f32 v133, v133
    v_exp_f32 v134, v134
    v_exp_f32 v135, v135
    v_cvt_pk_bf16_f32 v226, v132, v133
    v_cvt_pk_bf16_f32 v227, v134, v135
    v_mfma_f32_32x32x16_bf16 v[80:95], v[204:207], v[228:231], v[80:95]
    v_exp_f32 v136, v136
    v_exp_f32 v137, v137
    v_exp_f32 v138, v138
    v_exp_f32 v139, v139
    v_cvt_pk_bf16_f32 v228, v136, v137
    v_cvt_pk_bf16_f32 v229, v138, v139
    v_mfma_f32_32x32x16_bf16 v[96:111], v[200:203], v[224:227], v[96:111]
    v_exp_f32 v140, v140
    v_exp_f32 v141, v141
    v_exp_f32 v142, v142
    v_exp_f32 v143, v143
    v_cvt_pk_bf16_f32 v230, v140, v141
    v_cvt_pk_bf16_f32 v231, v142, v143
    v_mfma_f32_32x32x16_bf16 v[128:143], v[208:211], v[24:27], 0
    v_exp_f32 v112, v112
    v_exp_f32 v113, v113
    v_exp_f32 v114, v114
    v_exp_f32 v115, v115
    v_cvt_pk_bf16_f32 v224, v112, v113
    v_cvt_pk_bf16_f32 v225, v114, v115
    v_mfma_f32_32x32x16_bf16 v[128:143], v[212:215], v[28:31], v[128:143]
    v_exp_f32 v116, v116
    v_exp_f32 v117, v117
    v_exp_f32 v118, v118
    v_exp_f32 v119, v119
    v_cvt_pk_bf16_f32 v226, v116, v117
    v_cvt_pk_bf16_f32 v227, v118, v119
    v_mfma_f32_32x32x16_bf16 v[96:111], v[204:207], v[228:231], v[96:111]
    v_exp_f32 v120, v120
    v_exp_f32 v121, v121
    v_exp_f32 v122, v122
    v_exp_f32 v123, v123
    v_cvt_pk_bf16_f32 v228, v120, v121
    v_cvt_pk_bf16_f32 v229, v122, v123
    v_mfma_f32_32x32x16_bf16 v[48:63], v[216:219], v[224:227], v[48:63]
    v_exp_f32 v124, v124
    v_exp_f32 v125, v125
    v_exp_f32 v126, v126
    v_exp_f32 v127, v127
    v_cvt_pk_bf16_f32 v230, v124, v125
    v_cvt_pk_bf16_f32 v231, v126, v127
    s_waitcnt vmcnt(4)
    v_cmp_ne_u64 vcc, s[62:63], v[14:15]
    s_cbranch_vccnz L_gate2
L_gated2:
    s_nop 0
    v_mfma_f32_32x32x16_bf16 v[112:127], v[208:211], v[32:35], 0
    buffer_load_dwordx4 v[192:195], v240, s[24:27], s44 offen offset:0 sc1
    v_exp_f32 v128, v128
    v_exp_f32 v129, v129
    v_exp_f32 v130, v130
    v_exp_f32 v131, v131
    v_cvt_pk_bf16_f32 v224, v128, v129
    v_cvt_pk_bf16_f32 v225, v130, v131
    v_mfma_f32_32x32x16_bf16 v[112:127], v[212:215], v[36:39], v[112:127]
    buffer_load_dwordx4 v[196:199], v240, s[24:27], s44 offen offset:1024 sc1
    v_exp_f32 v132, v132
    v_exp_f32 v133, v133
    v_exp_f32 v134, v134
    v_exp_f32 v135, v135
    v_cvt_pk_bf16_f32 v226, v132, v133
    v_cvt_pk_bf16_f32 v227, v134, v135
    v_mfma_f32_32x32x16_bf16 v[48:63], v[220:223], v[228:231], v[48:63]
    buffer_load_dwordx4 v[200:203], v241, s[24:27], s44 offen offset:0 sc1
    v_exp_f32 v136, v136
    v_exp_f32 v137, v137
    v_exp_f32 v138, v138
    v_exp_f32 v139, v139
    v_cvt_pk_bf16_f32 v228, v136, v137
    v_cvt_pk_bf16_f32 v229, v138, v139
    v_mfma_f32_32x32x16_bf16 v[64:79], v[216:219], v[224:227], v[64:79]
    buffer_load_dwordx4 v[204:207], v241, s[24:27], s44 offen offset:1024 sc1
    v_exp_f32 v140, v140
    v_exp_f32 v141, v141
    v_exp_f32 v142, v142
    v_exp_f32 v143, v143
    v_cvt_pk_bf16_f32 v230, v140, v141
    v_cvt_pk_bf16_f32 v231, v142, v143
    v_mfma_f32_32x32x16_bf16 v[128:143], v[208:211], v[40:43], 0
    v_exp_f32 v112, v112
    v_exp_f32 v113, v113
    v_exp_f32 v114, v114
    v_exp_f32 v115, v115
    v_cvt_pk_bf16_f32 v224, v112, v113
    v_cvt_pk_bf16_f32 v225, v114, v115
    v_mfma_f32_32x32x16_bf16 v[128:143], v[212:215], v[44:47], v[128:143]
    v_exp_f32 v116, v116
    v_exp_f32 v117, v117
    v_exp_f32 v118, v118
    v_exp_f32 v119, v119
    v_cvt_pk_bf16_f32 v226, v116, v117
    v_cvt_pk_bf16_f32 v227, v118, v119
    v_mfma_f32_32x32x16_bf16 v[64:79], v[220:223], v[228:231], v[64:79]
    v_exp_f32 v120, v120
    v_exp_f32 v121, v121
    v_exp_f32 v122, v122
    v_exp_f32 v123, v123
    v_cvt_pk_bf16_f32 v228, v120, v121
    v_cvt_pk_bf16_f32 v229, v122, v123
    v_mfma_f32_32x32x16_bf16 v[80:95], v[216:219], v[224:227], v[80:95]
    v_exp_f32 v124, v124
    v_exp_f32 v125, v125
    v_exp_f32 v126, v126
    s_waitcnt vmcnt(13)
    v_exp_f32_e64 v127, v127
    v_cvt_pk_bf16_f32 v230, v124, v125
    v_cvt_pk_bf16_f32 v231, v126, v127
    v_mfma_f32_32x32x16_bf16 v[112:127], v[144:147], v[16:19], 0
    v_exp_f32 v128, v128
    v_exp_f32 v129, v129
    v_exp_f32 v130, v130
    v_exp_f32 v131, v131
    v_cvt_pk_bf16_f32 v224, v128, v129
    v_cvt_pk_bf16_f32 v225, v130, v131
    v_mfma_f32_32x32x16_bf16 v[112:127], v[148:151], v[20:23], v[112:127]
    v_exp_f32 v132, v132
    v_exp_f32 v133, v133
    v_exp_f32 v134, v134
    v_exp_f32 v135, v135
    v_cvt_pk_bf16_f32 v226, v132, v133
    v_cvt_pk_bf16_f32 v227, v134, v135
    v_mfma_f32_32x32x16_bf16 v[80:95], v[220:223], v[228:231], v[80:95]
    v_exp_f32 v136, v136
    v_exp_f32 v137, v137
    v_exp_f32 v138, v138
    v_exp_f32 v139, v139
    v_cvt_pk_bf16_f32 v228, v136, v137
    v_cvt_pk_bf16_f32 v229, v138, v139
    v_mfma_f32_32x32x16_bf16 v[96:111], v[216:219], v[224:227], v[96:111]
    v_exp_f32 v140, v140
    v_exp_f32 v141, v141
    v_exp_f32 v142, v142
    v_exp_f32 v143, v143
    v_cvt_pk_bf16_f32 v230, v140, v141
    v_cvt_pk_bf16_f32 v231, v142, v143
    v_mfma_f32_32x32x16_bf16 v[128:143], v[144:147], v[24:27], 0
    v_exp_f32 v112, v112
    v_exp_f32 v113, v113
    v_exp_f32 v114, v114
    v_exp_f32 v115, v115
    v_cvt_pk_bf16_f32 v224, v112, v113
    v_cvt_pk_bf16_f32 v225, v114, v115
    v_mfma_f32_32x32x16_bf16 v[128:143], v[148:151], v[28:31], v[128:143]
    v_exp_f32 v116, v116
    v_exp_f32 v117, v117
    v_exp_f32 v118, v118
    v_exp_f32 v119, v119
    v_cvt_pk_bf16_f32 v226, v116, v117
    v_cvt_pk_bf16_f32 v227, v118, v119
    v_mfma_f32_32x32x16_bf16 v[96:111], v[220:223], v[228:231], v[96:111]
    v_exp_f32 v120, v120
    v_exp_f32 v121, v121
    v_exp_f32 v122, v122
    v_exp_f32 v123, v123
    v_cvt_pk_bf16_f32 v228, v120, v121
    v_cvt_pk_bf16_f32 v229, v122, v123
    v_mfma_f32_32x32x16_bf16 v[48:63], v[152:155], v[224:227], v[48:63]
    v_exp_f32 v124, v124
    v_exp_f32 v125, v125
    v_exp_f32 v126, v126
    v_exp_f32 v127, v127
    v_cvt_pk_bf16_f32 v230, v124, v125
    v_cvt_pk_bf16_f32 v231, v126, v127
    v_mfma_f32_32x32x16_bf16 v[112:127], v[144:147], v[32:35], 0
    buffer_load_dwordx4 v[208:211], v240, s[24:27], s45 offen offset:0 sc1
    v_exp_f32 v128, v128
    v_exp_f32 v129, v129
    v_exp_f32 v130, v130
    v_exp_f32 v131, v131
    v_cvt_pk_bf16_f32 v224, v128, v129
    v_cvt_pk_bf16_f32 v225, v130, v131
    v_mfma_f32_32x32x16_bf16 v[112:127], v[148:151], v[36:39], v[112:127]
    buffer_load_dwordx4 v[212:215], v240, s[24:27], s45 offen offset:1024 sc1
    v_exp_f32 v132, v132
    v_exp_f32 v133, v133
    v_exp_f32 v134, v134
    v_exp_f32 v135, v135
    v_cvt_pk_bf16_f32 v226, v132, v133
    v_cvt_pk_bf16_f32 v227, v134, v135
    v_mfma_f32_32x32x16_bf16 v[48:63], v[156:159], v[228:231], v[48:63]
    buffer_load_dwordx4 v[216:219], v241, s[24:27], s45 offen offset:0 sc1
    v_exp_f32 v136, v136
    v_exp_f32 v137, v137
    v_exp_f32 v138, v138
    v_exp_f32 v139, v139
    v_cvt_pk_bf16_f32 v228, v136, v137
    v_cvt_pk_bf16_f32 v229, v138, v139
    v_mfma_f32_32x32x16_bf16 v[64:79], v[152:155], v[224:227], v[64:79]
    buffer_load_dwordx4 v[220:223], v241, s[24:27], s45 offen offset:1024 sc1
    v_exp_f32 v140, v140
    v_exp_f32 v141, v141
    v_exp_f32 v142, v142
    v_exp_f32 v143, v143
    v_cvt_pk_bf16_f32 v230, v140, v141
    v_cvt_pk_bf16_f32 v231, v142, v143
    v_mfma_f32_32x32x16_bf16 v[128:143], v[144:147], v[40:43], 0
    v_exp_f32 v112, v112
    v_exp_f32 v113, v113
    v_exp_f32 v114, v114
    v_exp_f32 v115, v115
    v_cvt_pk_bf16_f32 v224, v112, v113
    v_cvt_pk_bf16_f32 v225, v114, v115
    v_mfma_f32_32x32x16_bf16 v[128:143], v[148:151], v[44:47], v[128:143]
    v_exp_f32 v116, v116
    v_exp_f32 v117, v117
    v_exp_f32 v118, v118
    v_exp_f32 v119, v119
    v_cvt_pk_bf16_f32 v226, v116, v117
    v_cvt_pk_bf16_f32 v227, v118, v119
    v_mfma_f32_32x32x16_bf16 v[64:79], v[156:159], v[228:231], v[64:79]
    v_exp_f32 v120, v120
    v_exp_f32 v121, v121
    v_exp_f32 v122, v122
    v_exp_f32 v123, v123
    v_cvt_pk_bf16_f32 v228, v120, v121
    v_cvt_pk_bf16_f32 v229, v122, v123
    v_mfma_f32_32x32x16_bf16 v[80:95], v[152:155], v[224:227], v[80:95]
    v_exp_f32 v124, v124
    v_exp_f32 v125, v125
    v_exp_f32 v126, v126
    s_waitcnt vmcnt(13)
    v_exp_f32_e64 v127, v127
    v_cvt_pk_bf16_f32 v230, v124, v125
    v_cvt_pk_bf16_f32 v231, v126, v127
    v_mfma_f32_32x32x16_bf16 v[112:127], v[160:163], v[16:19], 0
    v_exp_f32 v128, v128
    v_exp_f32 v129, v129
    v_exp_f32 v130, v130
    v_exp_f32 v131, v131
    v_cvt_pk_bf16_f32 v224, v128, v129
    v_cvt_pk_bf16_f32 v225, v130, v131
    v_mfma_f32_32x32x16_bf16 v[112:127], v[164:167], v[20:23], v[112:127]
    v_exp_f32 v132, v132
    v_exp_f32 v133, v133
    v_exp_f32 v134, v134
    v_exp_f32 v135, v135
    v_cvt_pk_bf16_f32 v226, v132, v133
    v_cvt_pk_bf16_f32 v227, v134, v135
    v_mfma_f32_32x32x16_bf16 v[80:95], v[156:159], v[228:231], v[80:95]
    v_exp_f32 v136, v136
    v_exp_f32 v137, v137
    v_exp_f32 v138, v138
    v_exp_f32 v139, v139
    v_cvt_pk_bf16_f32 v228, v136, v137
    v_cvt_pk_bf16_f32 v229, v138, v139
    v_mfma_f32_32x32x16_bf16 v[96:111], v[152:155], v[224:227], v[96:111]
    v_exp_f32 v140, v140
    v_exp_f32 v141, v141
    v_exp_f32 v142, v142
    v_exp_f32 v143, v143
    v_cvt_pk_bf16_f32 v230, v140, v141
    v_cvt_pk_bf16_f32 v231, v142, v143
    v_mfma_f32_32x32x16_bf16 v[128:143], v[160:163], v[24:27], 0
    v_exp_f32 v112, v112
    v_exp_f32 v113, v113
    v_exp_f32 v114, v114
    v_exp_f32 v115, v115
    v_cvt_pk_bf16_f32 v224, v112, v113
    v_cvt_pk_bf16_f32 v225, v114, v115
    v_mfma_f32_32x32x16_bf16 v[128:143], v[164:167], v[28:31], v[128:143]
    v_exp_f32 v116, v116
    v_exp_f32 v117, v117
    v_exp_f32 v118, v118
    v_exp_f32 v119, v119
    v_cvt_pk_bf16_f32 v226, v116, v117
    v_cvt_pk_bf16_f32 v227, v118, v119
    v_mfma_f32_32x32x16_bf16 v[96:111], v[156:159], v[228:231], v[96:111]
    v_exp_f32 v120, v120
    v_exp_f32 v121, v121
    v_exp_f32 v122, v122
    v_exp_f32 v123, v123
    v_cvt_pk_bf16_f32 v228, v120, v121
    v_cvt_pk_bf16_f32 v229, v122, v123
    v_mfma_f32_32x32x16_bf16 v[48:63], v[168:171], v[224:227], v[48:63]
    v_exp_f32 v124, v124
    v_exp_f32 v125, v125
    v_exp_f32 v126, v126
    v_exp_f32 v127, v127
    v_cvt_pk_bf16_f32 v230, v124, v125
    v_cvt_pk_bf16_f32 v231, v126, v127
    v_mfma_f32_32x32x16_bf16 v[112:127], v[160:163], v[32:35], 0
    buffer_load_dwordx4 v[144:147], v240, s[24:27], s46 offen offset:0 sc1
    v_exp_f32 v128, v128
    v_exp_f32 v129, v129
    v_exp_f32 v130, v130
    v_exp_f32 v131, v131
    v_cvt_pk_bf16_f32 v224, v128, v129
    v_cvt_pk_bf16_f32 v225, v130, v131
    v_mfma_f32_32x32x16_bf16 v[112:127], v[164:167], v[36:39], v[112:127]
    buffer_load_dwordx4 v[148:151], v240, s[24:27], s46 offen offset:1024 sc1
    v_exp_f32 v132, v132
    v_exp_f32 v133, v133
    v_exp_f32 v134, v134
    v_exp_f32 v135, v135
    v_cvt_pk_bf16_f32 v226, v132, v133
    v_cvt_pk_bf16_f32 v227, v134, v135
    v_mfma_f32_32x32x16_bf16 v[48:63], v[172:175], v[228:231], v[48:63]
    buffer_load_dwordx4 v[152:155], v241, s[24:27], s46 offen offset:0 sc1
    v_exp_f32 v136, v136
    v_exp_f32 v137, v137
    v_exp_f32 v138, v138
    v_exp_f32 v139, v139
    v_cvt_pk_bf16_f32 v228, v136, v137
    v_cvt_pk_bf16_f32 v229, v138, v139
    v_mfma_f32_32x32x16_bf16 v[64:79], v[168:171], v[224:227], v[64:79]
    buffer_load_dwordx4 v[156:159], v241, s[24:27], s46 offen offset:1024 sc1
    v_exp_f32 v140, v140
    v_exp_f32 v141, v141
    v_exp_f32 v142, v142
    v_exp_f32 v143, v143
    v_cvt_pk_bf16_f32 v230, v140, v141
    v_cvt_pk_bf16_f32 v231, v142, v143
    v_mfma_f32_32x32x16_bf16 v[128:143], v[160:163], v[40:43], 0
    v_exp_f32 v112, v112
    v_exp_f32 v113, v113
    v_exp_f32 v114, v114
    v_exp_f32 v115, v115
    v_cvt_pk_bf16_f32 v224, v112, v113
    v_cvt_pk_bf16_f32 v225, v114, v115
    v_mfma_f32_32x32x16_bf16 v[128:143], v[164:167], v[44:47], v[128:143]
    v_exp_f32 v116, v116
    v_exp_f32 v117, v117
    v_exp_f32 v118, v118
    v_exp_f32 v119, v119
    v_cvt_pk_bf16_f32 v226, v116, v117
    v_cvt_pk_bf16_f32 v227, v118, v119
    v_mfma_f32_32x32x16_bf16 v[64:79], v[172:175], v[228:231], v[64:79]
    v_exp_f32 v120, v120
    v_exp_f32 v121, v121
    v_exp_f32 v122, v122
    v_exp_f32 v123, v123
    v_cvt_pk_bf16_f32 v228, v120, v121
    v_cvt_pk_bf16_f32 v229, v122, v123
    v_mfma_f32_32x32x16_bf16 v[80:95], v[168:171], v[224:227], v[80:95]
    v_exp_f32 v124, v124
    v_exp_f32 v125, v125
    v_exp_f32 v126, v126
    s_waitcnt vmcnt(12)
    v_exp_f32_e64 v127, v127
    v_cvt_pk_bf16_f32 v230, v124, v125
    v_cvt_pk_bf16_f32 v231, v126, v127
    v_mfma_f32_32x32x16_bf16 v[112:127], v[176:179], v[16:19], 0
    v_exp_f32 v128, v128
    v_exp_f32 v129, v129
    v_exp_f32 v130, v130
    v_exp_f32 v131, v131
    v_cvt_pk_bf16_f32 v224, v128, v129
    v_cvt_pk_bf16_f32 v225, v130, v131
    v_mfma_f32_32x32x16_bf16 v[112:127], v[180:183], v[20:23], v[112:127]
    v_exp_f32 v132, v132
    v_exp_f32 v133, v133
    v_exp_f32 v134, v134
    v_exp_f32 v135, v135
    v_cvt_pk_bf16_f32 v226, v132, v133
    v_cvt_pk_bf16_f32 v227, v134, v135
    v_mfma_f32_32x32x16_bf16 v[80:95], v[172:175], v[228:231], v[80:95]
    v_exp_f32 v136, v136
    v_exp_f32 v137, v137
    v_exp_f32 v138, v138
    v_exp_f32 v139, v139
    v_cvt_pk_bf16_f32 v228, v136, v137
    v_cvt_pk_bf16_f32 v229, v138, v139
    v_mfma_f32_32x32x16_bf16 v[96:111], v[168:171], v[224:227], v[96:111]
    v_exp_f32 v140, v140
    v_exp_f32 v141, v141
    v_exp_f32 v142, v142
    v_exp_f32 v143, v143
    v_cvt_pk_bf16_f32 v230, v140, v141
    v_cvt_pk_bf16_f32 v231, v142, v143
    v_mfma_f32_32x32x16_bf16 v[128:143], v[176:179], v[24:27], 0
    buffer_load_dwordx2 v[14:15], v242, s[24:27], s7 offen sc1
    v_exp_f32 v112, v112
    v_exp_f32 v113, v113
    v_exp_f32 v114, v114
    v_exp_f32 v115, v115
    v_cvt_pk_bf16_f32 v224, v112, v113
    v_cvt_pk_bf16_f32 v225, v114, v115
    v_mfma_f32_32x32x16_bf16 v[128:143], v[180:183], v[28:31], v[128:143]
    v_exp_f32 v116, v116
    v_exp_f32 v117, v117
    v_exp_f32 v118, v118
    v_exp_f32 v119, v119
    v_cvt_pk_bf16_f32 v226, v116, v117
    v_cvt_pk_bf16_f32 v227, v118, v119
    v_mfma_f32_32x32x16_bf16 v[96:111], v[172:175], v[228:231], v[96:111]
    v_exp_f32 v120, v120
    v_exp_f32 v121, v121
    v_exp_f32 v122, v122
    v_exp_f32 v123, v123
    v_cvt_pk_bf16_f32 v228, v120, v121
    v_cvt_pk_bf16_f32 v229, v122, v123
    v_mfma_f32_32x32x16_bf16 v[48:63], v[184:187], v[224:227], v[48:63]
    v_exp_f32 v124, v124
    v_exp_f32 v125, v125
    v_exp_f32 v126, v126
    v_exp_f32 v127, v127
    v_cvt_pk_bf16_f32 v230, v124, v125
    v_cvt_pk_bf16_f32 v231, v126, v127
    v_mfma_f32_32x32x16_bf16 v[112:127], v[176:179], v[32:35], 0
    buffer_load_dwordx4 v[160:163], v240, s[24:27], s47 offen offset:0 sc1
    v_exp_f32 v128, v128
    v_exp_f32 v129, v129
    v_exp_f32 v130, v130
    v_exp_f32 v131, v131
    v_cvt_pk_bf16_f32 v224, v128, v129
    v_cvt_pk_bf16_f32 v225, v130, v131
    v_mfma_f32_32x32x16_bf16 v[112:127], v[180:183], v[36:39], v[112:127]
    buffer_load_dwordx4 v[164:167], v240, s[24:27], s47 offen offset:1024 sc1
    v_exp_f32 v132, v132
    v_exp_f32 v133, v133
    v_exp_f32 v134, v134
    v_exp_f32 v135, v135
    v_cvt_pk_bf16_f32 v226, v132, v133
    v_cvt_pk_bf16_f32 v227, v134, v135
    v_mfma_f32_32x32x16_bf16 v[48:63], v[188:191], v[228:231], v[48:63]
    buffer_load_dwordx4 v[168:171], v241, s[24:27], s47 offen offset:0 sc1
    v_exp_f32 v136, v136
    v_exp_f32 v137, v137
    v_exp_f32 v138, v138
    v_exp_f32 v139, v139
    v_cvt_pk_bf16_f32 v228, v136, v137
    v_cvt_pk_bf16_f32 v229, v138, v139
    v_mfma_f32_32x32x16_bf16 v[64:79], v[184:187], v[224:227], v[64:79]
    buffer_load_dwordx4 v[172:175], v241, s[24:27], s47 offen offset:1024 sc1
    v_exp_f32 v140, v140
    v_exp_f32 v141, v141
    v_exp_f32 v142, v142
    v_exp_f32 v143, v143
    v_cvt_pk_bf16_f32 v230, v140, v141
    v_cvt_pk_bf16_f32 v231, v142, v143
    v_mfma_f32_32x32x16_bf16 v[128:143], v[176:179], v[40:43], 0
    v_exp_f32 v112, v112
    v_exp_f32 v113, v113
    v_exp_f32 v114, v114
    v_exp_f32 v115, v115
    v_cvt_pk_bf16_f32 v224, v112, v113
    v_cvt_pk_bf16_f32 v225, v114, v115
    v_mfma_f32_32x32x16_bf16 v[128:143], v[180:183], v[44:47], v[128:143]
    v_exp_f32 v116, v116
    v_exp_f32 v117, v117
    v_exp_f32 v118, v118
    v_exp_f32 v119, v119
    v_cvt_pk_bf16_f32 v226, v116, v117
    v_cvt_pk_bf16_f32 v227, v118, v119
    v_mfma_f32_32x32x16_bf16 v[64:79], v[188:191], v[228:231], v[64:79]
    v_exp_f32 v120, v120
    v_exp_f32 v121, v121
    v_exp_f32 v122, v122
    v_exp_f32 v123, v123
    v_cvt_pk_bf16_f32 v228, v120, v121
    v_cvt_pk_bf16_f32 v229, v122, v123
    v_mfma_f32_32x32x16_bf16 v[80:95], v[184:187], v[224:227], v[80:95]
    v_exp_f32 v124, v124
    v_exp_f32 v125, v125
    v_exp_f32 v126, v126
    s_waitcnt vmcnt(13)
    v_exp_f32_e64 v127, v127
    v_cvt_pk_bf16_f32 v230, v124, v125
    v_cvt_pk_bf16_f32 v231, v126, v127
    v_mfma_f32_32x32x16_bf16 v[112:127], v[192:195], v[16:19], 0
    v_exp_f32 v128, v128
    v_exp_f32 v129, v129
    v_exp_f32 v130, v130
    v_exp_f32 v131, v131
    v_cvt_pk_bf16_f32 v224, v128, v129
    v_cvt_pk_bf16_f32 v225, v130, v131
    v_mfma_f32_32x32x16_bf16 v[112:127], v[196:199], v[20:23], v[112:127]
    v_exp_f32 v132, v132
    v_exp_f32 v133, v133
    v_exp_f32 v134, v134
    v_exp_f32 v135, v135
    v_cvt_pk_bf16_f32 v226, v132, v133
    v_cvt_pk_bf16_f32 v227, v134, v135
    v_mfma_f32_32x32x16_bf16 v[80:95], v[188:191], v[228:231], v[80:95]
    v_exp_f32 v136, v136
    v_exp_f32 v137, v137
    v_exp_f32 v138, v138
    v_exp_f32 v139, v139
    v_cvt_pk_bf16_f32 v228, v136, v137
    v_cvt_pk_bf16_f32 v229, v138, v139
    v_mfma_f32_32x32x16_bf16 v[96:111], v[184:187], v[224:227], v[96:111]
    v_exp_f32 v140, v140
    v_exp_f32 v141, v141
    v_exp_f32 v142, v142
    v_exp_f32 v143, v143
    v_cvt_pk_bf16_f32 v230, v140, v141
    v_cvt_pk_bf16_f32 v231, v142, v143
    v_mfma_f32_32x32x16_bf16 v[128:143], v[192:195], v[24:27], 0
    v_exp_f32 v112, v112
    v_exp_f32 v113, v113
    v_exp_f32 v114, v114
    v_exp_f32 v115, v115
    v_cvt_pk_bf16_f32 v224, v112, v113
    v_cvt_pk_bf16_f32 v225, v114, v115
    v_mfma_f32_32x32x16_bf16 v[128:143], v[196:199], v[28:31], v[128:143]
    v_exp_f32 v116, v116
    v_exp_f32 v117, v117
    v_exp_f32 v118, v118
    v_exp_f32 v119, v119
    v_cvt_pk_bf16_f32 v226, v116, v117
    v_cvt_pk_bf16_f32 v227, v118, v119
    v_mfma_f32_32x32x16_bf16 v[96:111], v[188:191], v[228:231], v[96:111]
    v_exp_f32 v120, v120
    v_exp_f32 v121, v121
    v_exp_f32 v122, v122
    v_exp_f32 v123, v123
    v_cvt_pk_bf16_f32 v228, v120, v121
    v_cvt_pk_bf16_f32 v229, v122, v123
    v_mfma_f32_32x32x16_bf16 v[48:63], v[200:203], v[224:227], v[48:63]
    v_exp_f32 v124, v124
    v_exp_f32 v125, v125
    v_exp_f32 v126, v126
    v_exp_f32 v127, v127
    v_cvt_pk_bf16_f32 v230, v124, v125
    v_cvt_pk_bf16_f32 v231, v126, v127
    s_waitcnt vmcnt(4)
    v_cmp_ne_u64 vcc, s[62:63], v[14:15]
    s_cbranch_vccnz L_gate3
L_gated3:
    s_nop 0
    v_mfma_f32_32x32x16_bf16 v[112:127], v[192:195], v[32:35], 0
    buffer_load_dwordx4 v[176:179], v240, s[24:27], s48 offen offset:0 sc1
    v_exp_f32 v128, v128
    v_exp_f32 v129, v129
    v_exp_f32 v130, v130
    v_exp_f32 v131, v131
    v_cvt_pk_bf16_f32 v224, v128, v129
    v_cvt_pk_bf16_f32 v225, v130, v131
    v_mfma_f32_32x32x16_bf16 v[112:127], v[196:199], v[36:39], v[112:127]
    buffer_load_dwordx4 v[180:183], v240, s[24:27], s48 offen offset:1024 sc1
    v_exp_f32 v132, v132
    v_exp_f32 v133, v133
    v_exp_f32 v134, v134
    v_exp_f32 v135, v135
    v_cvt_pk_bf16_f32 v226, v132, v133
    v_cvt_pk_bf16_f32 v227, v134, v135
    v_mfma_f32_32x32x16_bf16 v[48:63], v[204:207], v[228:231], v[48:63]
    buffer_load_dwordx4 v[184:187], v241, s[24:27], s48 offen offset:0 sc1
    v_exp_f32 v136, v136
    v_exp_f32 v137, v137
    v_exp_f32 v138, v138
    v_exp_f32 v139, v139
    v_cvt_pk_bf16_f32 v228, v136, v137
    v_cvt_pk_bf16_f32 v229, v138, v139
    v_mfma_f32_32x32x16_bf16 v[64:79], v[200:203], v[224:227], v[64:79]
    buffer_load_dwordx4 v[188:191], v241, s[24:27], s48 offen offset:1024 sc1
    v_exp_f32 v140, v140
    v_exp_f32 v141, v141
    v_exp_f32 v142, v142
    v_exp_f32 v143, v143
    v_cvt_pk_bf16_f32 v230, v140, v141
    v_cvt_pk_bf16_f32 v231, v142, v143
    v_mfma_f32_32x32x16_bf16 v[128:143], v[192:195], v[40:43], 0
    v_exp_f32 v112, v112
    v_exp_f32 v113, v113
    v_exp_f32 v114, v114
    v_exp_f32 v115, v115
    v_cvt_pk_bf16_f32 v224, v112, v113
    v_cvt_pk_bf16_f32 v225, v114, v115
    v_mfma_f32_32x32x16_bf16 v[128:143], v[196:199], v[44:47], v[128:143]
    v_exp_f32 v116, v116
    v_exp_f32 v117, v117
    v_exp_f32 v118, v118
    v_exp_f32 v119, v119
    v_cvt_pk_bf16_f32 v226, v116, v117
    v_cvt_pk_bf16_f32 v227, v118, v119
    v_mfma_f32_32x32x16_bf16 v[64:79], v[204:207], v[228:231], v[64:79]
    v_exp_f32 v120, v120
    v_exp_f32 v121, v121
    v_exp_f32 v122, v122
    v_exp_f32 v123, v123
    v_cvt_pk_bf16_f32 v228, v120, v121
    v_cvt_pk_bf16_f32 v229, v122, v123
    v_mfma_f32_32x32x16_bf16 v[80:95], v[200:203], v[224:227], v[80:95]
    v_exp_f32 v124, v124
    v_exp_f32 v125, v125
    v_exp_f32 v126, v126
    s_waitcnt vmcnt(13)
    v_exp_f32_e64 v127, v127
    v_cvt_pk_bf16_f32 v230, v124, v125
    v_cvt_pk_bf16_f32 v231, v126, v127
    v_mfma_f32_32x32x16_bf16 v[112:127], v[208:211], v[16:19], 0
    v_exp_f32 v128, v128
    v_exp_f32 v129, v129
    v_exp_f32 v130, v130
    v_exp_f32 v131, v131
    v_cvt_pk_bf16_f32 v224, v128, v129
    v_cvt_pk_bf16_f32 v225, v130, v131
    v_mfma_f32_32x32x16_bf16 v[112:127], v[212:215], v[20:23], v[112:127]
    v_exp_f32 v132, v132
    v_exp_f32 v133, v133
    v_exp_f32 v134, v134
    v_exp_f32 v135, v135
    v_cvt_pk_bf16_f32 v226, v132, v133
    v_cvt_pk_bf16_f32 v227, v134, v135
    v_mfma_f32_32x32x16_bf16 v[80:95], v[204:207], v[228:231], v[80:95]
    v_exp_f32 v136, v136
    v_exp_f32 v137, v137
    v_exp_f32 v138, v138
    v_exp_f32 v139, v139
    v_cvt_pk_bf16_f32 v228, v136, v137
    v_cvt_pk_bf16_f32 v229, v138, v139
    v_mfma_f32_32x32x16_bf16 v[96:111], v[200:203], v[224:227], v[96:111]
    v_exp_f32 v140, v140
    v_exp_f32 v141, v141
    v_exp_f32 v142, v142
    v_exp_f32 v143, v143
    v_cvt_pk_bf16_f32 v230, v140, v141
    v_cvt_pk_bf16_f32 v231, v142, v143
    v_mfma_f32_32x32x16_bf16 v[128:143], v[208:211], v[24:27], 0
    v_exp_f32 v112, v112
    v_exp_f32 v113, v113
    v_exp_f32 v114, v114
    v_exp_f32 v115, v115
    v_cvt_pk_bf16_f32 v224, v112, v113
    v_cvt_pk_bf16_f32 v225, v114, v115
    v_mfma_f32_32x32x16_bf16 v[128:143], v[212:215], v[28:31], v[128:143]
    v_exp_f32 v116, v116
    v_exp_f32 v117, v117
    v_exp_f32 v118, v118
    v_exp_f32 v119, v119
    v_cvt_pk_bf16_f32 v226, v116, v117
    v_cvt_pk_bf16_f32 v227, v118, v119
    v_mfma_f32_32x32x16_bf16 v[96:111], v[204:207], v[228:231], v[96:111]
    v_exp_f32 v120, v120
    v_exp_f32 v121, v121
    v_exp_f32 v122, v122
    v_exp_f32 v123, v123
    v_cvt_pk_bf16_f32 v228, v120, v121
    v_cvt_pk_bf16_f32 v229, v122, v123
    v_mfma_f32_32x32x16_bf16 v[48:63], v[216:219], v[224:227], v[48:63]
    v_exp_f32 v124, v124
    v_exp_f32 v125, v125
    v_exp_f32 v126, v126
    v_exp_f32 v127, v127
    v_cvt_pk_bf16_f32 v230, v124, v125
    v_cvt_pk_bf16_f32 v231, v126, v127
    v_mfma_f32_32x32x16_bf16 v[112:127], v[208:211], v[32:35], 0
    buffer_load_dwordx4 v[192:195], v240, s[24:27], s49 offen offset:0 sc1
    v_exp_f32 v128, v128
    v_exp_f32 v129, v129
    v_exp_f32 v130, v130
    v_exp_f32 v131, v131
    v_cvt_pk_bf16_f32 v224, v128, v129
    v_cvt_pk_bf16_f32 v225, v130, v131
    v_mfma_f32_32x32x16_bf16 v[112:127], v[212:215], v[36:39], v[112:127]
    buffer_load_dwordx4 v[196:199], v240, s[24:27], s49 offen offset:1024 sc1
    v_exp_f32 v132, v132
    v_exp_f32 v133, v133
    v_exp_f32 v134, v134
    v_exp_f32 v135, v135
    v_cvt_pk_bf16_f32 v226, v132, v133
    v_cvt_pk_bf16_f32 v227, v134, v135
    v_mfma_f32_32x32x16_bf16 v[48:63], v[220:223], v[228:231], v[48:63]
    buffer_load_dwordx4 v[200:203], v241, s[24:27], s49 offen offset:0 sc1
    v_exp_f32 v136, v136
    v_exp_f32 v137, v137
    v_exp_f32 v138, v138
    v_exp_f32 v139, v139
    v_cvt_pk_bf16_f32 v228, v136, v137
    v_cvt_pk_bf16_f32 v229, v138, v139
    v_mfma_f32_32x32x16_bf16 v[64:79], v[216:219], v[224:227], v[64:79]
    buffer_load_dwordx4 v[204:207], v241, s[24:27], s49 offen offset:1024 sc1
    v_exp_f32 v140, v140
    v_exp_f32 v141, v141
    v_exp_f32 v142, v142
    v_exp_f32 v143, v143
    v_cvt_pk_bf16_f32 v230, v140, v141
    v_cvt_pk_bf16_f32 v231, v142, v143
    v_mfma_f32_32x32x16_bf16 v[128:143], v[208:211], v[40:43], 0
    v_exp_f32 v112, v112
    v_exp_f32 v113, v113
    v_exp_f32 v114, v114
    v_exp_f32 v115, v115
    v_cvt_pk_bf16_f32 v224, v112, v113
    v_cvt_pk_bf16_f32 v225, v114, v115
    v_mfma_f32_32x32x16_bf16 v[128:143], v[212:215], v[44:47], v[128:143]
    v_exp_f32 v116, v116
    v_exp_f32 v117, v117
    v_exp_f32 v118, v118
    v_exp_f32 v119, v119
    v_cvt_pk_bf16_f32 v226, v116, v117
    v_cvt_pk_bf16_f32 v227, v118, v119
    v_mfma_f32_32x32x16_bf16 v[64:79], v[220:223], v[228:231], v[64:79]
    v_exp_f32 v120, v120
    v_exp_f32 v121, v121
    v_exp_f32 v122, v122
    v_exp_f32 v123, v123
    v_cvt_pk_bf16_f32 v228, v120, v121
    v_cvt_pk_bf16_f32 v229, v122, v123
    v_mfma_f32_32x32x16_bf16 v[80:95], v[216:219], v[224:227], v[80:95]
    v_exp_f32 v124, v124
    v_exp_f32 v125, v125
    v_exp_f32 v126, v126
    s_waitcnt vmcnt(13)
    v_exp_f32_e64 v127, v127
    v_cvt_pk_bf16_f32 v230, v124, v125
    v_cvt_pk_bf16_f32 v231, v126, v127
    v_mfma_f32_32x32x16_bf16 v[112:127], v[144:147], v[16:19], 0
    v_exp_f32 v128, v128
    v_exp_f32 v129, v129
    v_exp_f32 v130, v130
    v_exp_f32 v131, v131
    v_cvt_pk_bf16_f32 v224, v128, v129
    v_cvt_pk_bf16_f32 v225, v130, v131
    v_mfma_f32_32x32x16_bf16 v[112:127], v[148:151], v[20:23], v[112:127]
    v_exp_f32 v132, v132
    v_exp_f32 v133, v133
    v_exp_f32 v134, v134
    v_exp_f32 v135, v135
    v_cvt_pk_bf16_f32 v226, v132, v133
    v_cvt_pk_bf16_f32 v227, v134, v135
    v_mfma_f32_32x32x16_bf16 v[80:95], v[220:223], v[228:231], v[80:95]
    v_exp_f32 v136, v136
    v_exp_f32 v137, v137
    v_exp_f32 v138, v138
    v_exp_f32 v139, v139
    v_cvt_pk_bf16_f32 v228, v136, v137
    v_cvt_pk_bf16_f32 v229, v138, v139
    v_mfma_f32_32x32x16_bf16 v[96:111], v[216:219], v[224:227], v[96:111]
    v_exp_f32 v140, v140
    v_exp_f32 v141, v141
    v_exp_f32 v142, v142
    v_exp_f32 v143, v143
    v_cvt_pk_bf16_f32 v230, v140, v141
    v_cvt_pk_bf16_f32 v231, v142, v143
    v_mfma_f32_32x32x16_bf16 v[128:143], v[144:147], v[24:27], 0
    v_exp_f32 v112, v112
    v_exp_f32 v113, v113
    v_exp_f32 v114, v114
    v_exp_f32 v115, v115
    v_cvt_pk_bf16_f32 v224, v112, v113
    v_cvt_pk_bf16_f32 v225, v114, v115
    v_mfma_f32_32x32x16_bf16 v[128:143], v[148:151], v[28:31], v[128:143]
    v_exp_f32 v116, v116
    v_exp_f32 v117, v117
    v_exp_f32 v118, v118
    v_exp_f32 v119, v119
    v_cvt_pk_bf16_f32 v226, v116, v117
    v_cvt_pk_bf16_f32 v227, v118, v119
    v_mfma_f32_32x32x16_bf16 v[96:111], v[220:223], v[228:231], v[96:111]
    v_exp_f32 v120, v120
    v_exp_f32 v121, v121
    v_exp_f32 v122, v122
    v_exp_f32 v123, v123
    v_cvt_pk_bf16_f32 v228, v120, v121
    v_cvt_pk_bf16_f32 v229, v122, v123
    v_mfma_f32_32x32x16_bf16 v[48:63], v[152:155], v[224:227], v[48:63]
    v_exp_f32 v124, v124
    v_exp_f32 v125, v125
    v_exp_f32 v126, v126
    v_exp_f32 v127, v127
    v_cvt_pk_bf16_f32 v230, v124, v125
    v_cvt_pk_bf16_f32 v231, v126, v127
    v_mfma_f32_32x32x16_bf16 v[112:127], v[144:147], v[32:35], 0
    buffer_load_dwordx4 v[208:211], v240, s[24:27], s50 offen offset:0 sc1
    v_exp_f32 v128, v128
    v_exp_f32 v129, v129
    v_exp_f32 v130, v130
    v_exp_f32 v131, v131
    v_cvt_pk_bf16_f32 v224, v128, v129
    v_cvt_pk_bf16_f32 v225, v130, v131
    v_mfma_f32_32x32x16_bf16 v[112:127], v[148:151], v[36:39], v[112:127]
    buffer_load_dwordx4 v[212:215], v240, s[24:27], s50 offen offset:1024 sc1
    v_exp_f32 v132, v132
    v_exp_f32 v133, v133
    v_exp_f32 v134, v134
    v_exp_f32 v135, v135
    v_cvt_pk_bf16_f32 v226, v132, v133
    v_cvt_pk_bf16_f32 v227, v134, v135
    v_mfma_f32_32x32x16_bf16 v[48:63], v[156:159], v[228:231], v[48:63]
    buffer_load_dwordx4 v[216:219], v241, s[24:27], s50 offen offset:0 sc1
    v_exp_f32 v136, v136
    v_exp_f32 v137, v137
    v_exp_f32 v138, v138
    v_exp_f32 v139, v139
    v_cvt_pk_bf16_f32 v228, v136, v137
    v_cvt_pk_bf16_f32 v229, v138, v139
    v_mfma_f32_32x32x16_bf16 v[64:79], v[152:155], v[224:227], v[64:79]
    buffer_load_dwordx4 v[220:223], v241, s[24:27], s50 offen offset:1024 sc1
    v_exp_f32 v140, v140
    v_exp_f32 v141, v141
    v_exp_f32 v142, v142
    v_exp_f32 v143, v143
    v_cvt_pk_bf16_f32 v230, v140, v141
    v_cvt_pk_bf16_f32 v231, v142, v143
    v_mfma_f32_32x32x16_bf16 v[128:143], v[144:147], v[40:43], 0
    v_exp_f32 v112, v112
    v_exp_f32 v113, v113
    v_exp_f32 v114, v114
    v_exp_f32 v115, v115
    v_cvt_pk_bf16_f32 v224, v112, v113
    v_cvt_pk_bf16_f32 v225, v114, v115
    v_mfma_f32_32x32x16_bf16 v[128:143], v[148:151], v[44:47], v[128:143]
    v_exp_f32 v116, v116
    v_exp_f32 v117, v117
    v_exp_f32 v118, v118
    v_exp_f32 v119, v119
    v_cvt_pk_bf16_f32 v226, v116, v117
    v_cvt_pk_bf16_f32 v227, v118, v119
    v_mfma_f32_32x32x16_bf16 v[64:79], v[156:159], v[228:231], v[64:79]
    v_exp_f32 v120, v120
    v_exp_f32 v121, v121
    v_exp_f32 v122, v122
    v_exp_f32 v123, v123
    v_cvt_pk_bf16_f32 v228, v120, v121
    v_cvt_pk_bf16_f32 v229, v122, v123
    v_mfma_f32_32x32x16_bf16 v[80:95], v[152:155], v[224:227], v[80:95]
    v_exp_f32 v124, v124
    v_exp_f32 v125, v125
    v_exp_f32 v126, v126
    s_waitcnt vmcnt(12)
    v_exp_f32_e64 v127, v127
    v_cvt_pk_bf16_f32 v230, v124, v125
    v_cvt_pk_bf16_f32 v231, v126, v127
    v_mfma_f32_32x32x16_bf16 v[112:127], v[160:163], v[16:19], 0
    v_exp_f32 v128, v128
    v_exp_f32 v129, v129
    v_exp_f32 v130, v130
    v_exp_f32 v131, v131
    v_cvt_pk_bf16_f32 v224, v128, v129
    v_cvt_pk_bf16_f32 v225, v130, v131
    v_mfma_f32_32x32x16_bf16 v[112:127], v[164:167], v[20:23], v[112:127]
    v_exp_f32 v132, v132
    v_exp_f32 v133, v133
    v_exp_f32 v134, v134
    v_exp_f32 v135, v135
    v_cvt_pk_bf16_f32 v226, v132, v133
    v_cvt_pk_bf16_f32 v227, v134, v135
    v_mfma_f32_32x32x16_bf16 v[80:95], v[156:159], v[228:231], v[80:95]
    v_exp_f32 v136, v136
    v_exp_f32 v137, v137
    v_exp_f32 v138, v138
    v_exp_f32 v139, v139
    v_cvt_pk_bf16_f32 v228, v136, v137
    v_cvt_pk_bf16_f32 v229, v138, v139
    v_mfma_f32_32x32x16_bf16 v[96:111], v[152:155], v[224:227], v[96:111]
    v_exp_f32 v140, v140
    v_exp_f32 v141, v141
    v_exp_f32 v142, v142
    v_exp_f32 v143, v143
    v_cvt_pk_bf16_f32 v230, v140, v141
    v_cvt_pk_bf16_f32 v231, v142, v143
    v_mfma_f32_32x32x16_bf16 v[128:143], v[160:163], v[24:27], 0
    v_exp_f32 v112, v112
    v_exp_f32 v113, v113
    v_exp_f32 v114, v114
    v_exp_f32 v115, v115
    v_cvt_pk_bf16_f32 v224, v112, v113
    v_cvt_pk_bf16_f32 v225, v114, v115
    v_mfma_f32_32x32x16_bf16 v[128:143], v[164:167], v[28:31], v[128:143]
    v_exp_f32 v116, v116
    v_exp_f32 v117, v117
    v_exp_f32 v118, v118
    v_exp_f32 v119, v119
    v_cvt_pk_bf16_f32 v226, v116, v117
    v_cvt_pk_bf16_f32 v227, v118, v119
    v_mfma_f32_32x32x16_bf16 v[96:111], v[156:159], v[228:231], v[96:111]
    v_exp_f32 v120, v120
    v_exp_f32 v121, v121
    v_exp_f32 v122, v122
    v_exp_f32 v123, v123
    v_cvt_pk_bf16_f32 v228, v120, v121
    v_cvt_pk_bf16_f32 v229, v122, v123
    v_mfma_f32_32x32x16_bf16 v[48:63], v[168:171], v[224:227], v[48:63]
    v_exp_f32 v124, v124
    v_exp_f32 v125, v125
    v_exp_f32 v126, v126
    v_exp_f32 v127, v127
    v_cvt_pk_bf16_f32 v230, v124, v125
    v_cvt_pk_bf16_f32 v231, v126, v127
    v_mfma_f32_32x32x16_bf16 v[112:127], v[160:163], v[32:35], 0
    buffer_load_dwordx4 v[144:147], v240, s[24:27], s51 offen offset:0 sc1
    v_exp_f32 v128, v128
    v_exp_f32 v129, v129
    v_exp_f32 v130, v130
    v_exp_f32 v131, v131
    v_cvt_pk_bf16_f32 v224, v128, v129
    v_cvt_pk_bf16_f32 v225, v130, v131
    v_mfma_f32_32x32x16_bf16 v[112:127], v[164:167], v[36:39], v[112:127]
    buffer_load_dwordx4 v[148:151], v240, s[24:27], s51 offen offset:1024 sc1
    v_exp_f32 v132, v132
    v_exp_f32 v133, v133
    v_exp_f32 v134, v134
    v_exp_f32 v135, v135
    v_cvt_pk_bf16_f32 v226, v132, v133
    v_cvt_pk_bf16_f32 v227, v134, v135
    v_mfma_f32_32x32x16_bf16 v[48:63], v[172:175], v[228:231], v[48:63]
    buffer_load_dwordx4 v[152:155], v241, s[24:27], s51 offen offset:0 sc1
    v_exp_f32 v136, v136
    v_exp_f32 v137, v137
    v_exp_f32 v138, v138
    v_exp_f32 v139, v139
    v_cvt_pk_bf16_f32 v228, v136, v137
    v_cvt_pk_bf16_f32 v229, v138, v139
    v_mfma_f32_32x32x16_bf16 v[64:79], v[168:171], v[224:227], v[64:79]
    buffer_load_dwordx4 v[156:159], v241, s[24:27], s51 offen offset:1024 sc1
    v_exp_f32 v140, v140
    v_exp_f32 v141, v141
    v_exp_f32 v142, v142
    v_exp_f32 v143, v143
    v_cvt_pk_bf16_f32 v230, v140, v141
    v_cvt_pk_bf16_f32 v231, v142, v143
    v_mfma_f32_32x32x16_bf16 v[128:143], v[160:163], v[40:43], 0
    v_exp_f32 v112, v112
    v_exp_f32 v113, v113
    v_exp_f32 v114, v114
    v_exp_f32 v115, v115
    v_cvt_pk_bf16_f32 v224, v112, v113
    v_cvt_pk_bf16_f32 v225, v114, v115
    v_mfma_f32_32x32x16_bf16 v[128:143], v[164:167], v[44:47], v[128:143]
    v_exp_f32 v116, v116
    v_exp_f32 v117, v117
    v_exp_f32 v118, v118
    v_exp_f32 v119, v119
    v_cvt_pk_bf16_f32 v226, v116, v117
    v_cvt_pk_bf16_f32 v227, v118, v119
    v_mfma_f32_32x32x16_bf16 v[64:79], v[172:175], v[228:231], v[64:79]
    v_exp_f32 v120, v120
    v_exp_f32 v121, v121
    v_exp_f32 v122, v122
    v_exp_f32 v123, v123
    v_cvt_pk_bf16_f32 v228, v120, v121
    v_cvt_pk_bf16_f32 v229, v122, v123
    v_mfma_f32_32x32x16_bf16 v[80:95], v[168:171], v[224:227], v[80:95]
    v_exp_f32 v124, v124
    v_exp_f32 v125, v125
    v_exp_f32 v126, v126
    s_waitcnt vmcnt(12)
    v_exp_f32_e64 v127, v127
    v_cvt_pk_bf16_f32 v230, v124, v125
    v_cvt_pk_bf16_f32 v231, v126, v127
    v_mfma_f32_32x32x16_bf16 v[112:127], v[176:179], v[16:19], 0
    v_exp_f32 v128, v128
    v_exp_f32 v129, v129
    v_exp_f32 v130, v130
    v_exp_f32 v131, v131
    v_cvt_pk_bf16_f32 v224, v128, v129
    v_cvt_pk_bf16_f32 v225, v130, v131
    v_mfma_f32_32x32x16_bf16 v[112:127], v[180:183], v[20:23], v[112:127]
    v_exp_f32 v132, v132
    v_exp_f32 v133, v133
    v_exp_f32 v134, v134
    v_exp_f32 v135, v135
    v_cvt_pk_bf16_f32 v226, v132, v133
    v_cvt_pk_bf16_f32 v227, v134, v135
    v_mfma_f32_32x32x16_bf16 v[80:95], v[172:175], v[228:231], v[80:95]
    v_exp_f32 v136, v136
    v_exp_f32 v137, v137
    v_exp_f32 v138, v138
    v_exp_f32 v139, v139
    v_cvt_pk_bf16_f32 v228, v136, v137
    v_cvt_pk_bf16_f32 v229, v138, v139
    v_mfma_f32_32x32x16_bf16 v[96:111], v[168:171], v[224:227], v[96:111]
    v_exp_f32 v140, v140
    v_exp_f32 v141, v141
    v_exp_f32 v142, v142
    s_waitcnt vmcnt(8)
    v_exp_f32_e64 v143, v143
    v_cvt_pk_bf16_f32 v230, v140, v141
    v_cvt_pk_bf16_f32 v231, v142, v143
    v_mfma_f32_32x32x16_bf16 v[128:143], v[192:195], v[16:19], 0
    v_exp_f32 v112, v112
    v_exp_f32 v113, v113
    v_exp_f32 v114, v114
    v_exp_f32 v115, v115
    v_cvt_pk_bf16_f32 v224, v112, v113
    v_cvt_pk_bf16_f32 v225, v114, v115
    v_mfma_f32_32x32x16_bf16 v[128:143], v[196:199], v[20:23], v[128:143]
    v_exp_f32 v116, v116
    v_exp_f32 v117, v117
    v_exp_f32 v118, v118
    v_exp_f32 v119, v119
    v_cvt_pk_bf16_f32 v226, v116, v117
    v_cvt_pk_bf16_f32 v227, v118, v119
    v_mfma_f32_32x32x16_bf16 v[96:111], v[172:175], v[228:231], v[96:111]
    v_exp_f32 v120, v120
    v_exp_f32 v121, v121
    v_exp_f32 v122, v122
    v_exp_f32 v123, v123
    v_cvt_pk_bf16_f32 v228, v120, v121
    v_cvt_pk_bf16_f32 v229, v122, v123
    v_mfma_f32_32x32x16_bf16 v[48:63], v[184:187], v[224:227], v[48:63]
    v_exp_f32 v124, v124
    v_exp_f32 v125, v125
    v_exp_f32 v126, v126
    s_waitcnt vmcnt(4)
    v_exp_f32_e64 v127, v127
    v_cvt_pk_bf16_f32 v230, v124, v125
    v_cvt_pk_bf16_f32 v231, v126, v127
    v_mfma_f32_32x32x16_bf16 v[112:127], v[208:211], v[16:19], 0
    v_exp_f32 v128, v128
    v_exp_f32 v129, v129
    v_exp_f32 v130, v130
    v_exp_f32 v131, v131
    v_cvt_pk_bf16_f32 v224, v128, v129
    v_cvt_pk_bf16_f32 v225, v130, v131
    v_mfma_f32_32x32x16_bf16 v[112:127], v[212:215], v[20:23], v[112:127]
    v_exp_f32 v132, v132
    v_exp_f32 v133, v133
    v_exp_f32 v134, v134
    v_exp_f32 v135, v135
    v_cvt_pk_bf16_f32 v226, v132, v133
    v_cvt_pk_bf16_f32 v227, v134, v135
    v_mfma_f32_32x32x16_bf16 v[48:63], v[188:191], v[228:231], v[48:63]
    v_exp_f32 v136, v136
    v_exp_f32 v137, v137
    v_exp_f32 v138, v138
    v_exp_f32 v139, v139
    v_cvt_pk_bf16_f32 v228, v136, v137
    v_cvt_pk_bf16_f32 v229, v138, v139
    v_mfma_f32_32x32x16_bf16 v[48:63], v[200:203], v[224:227], v[48:63]
    v_exp_f32 v140, v140
    v_exp_f32 v141, v141
    v_exp_f32 v142, v142
    s_waitcnt vmcnt(0)
    v_exp_f32_e64 v143, v143
    v_cvt_pk_bf16_f32 v230, v140, v141
    v_cvt_pk_bf16_f32 v231, v142, v143
    v_mfma_f32_32x32x16_bf16 v[128:143], v[144:147], v[16:19], 0
    v_exp_f32 v112, v112
    v_exp_f32 v113, v113
    v_exp_f32 v114, v114
    v_exp_f32 v115, v115
    v_cvt_pk_bf16_f32 v224, v112, v113
    v_cvt_pk_bf16_f32 v225, v114, v115
    v_mfma_f32_32x32x16_bf16 v[128:143], v[148:151], v[20:23], v[128:143]
    v_exp_f32 v116, v116
    v_exp_f32 v117, v117
    v_exp_f32 v118, v118
    v_exp_f32 v119, v119
    v_cvt_pk_bf16_f32 v226, v116, v117
    v_cvt_pk_bf16_f32 v227, v118, v119
    v_mfma_f32_32x32x16_bf16 v[48:63], v[204:207], v[228:231], v[48:63]
    v_exp_f32 v120, v120
    v_exp_f32 v121, v121
    v_exp_f32 v122, v122
    v_exp_f32 v123, v123
    v_cvt_pk_bf16_f32 v228, v120, v121
    v_cvt_pk_bf16_f32 v229, v122, v123
    v_mfma_f32_32x32x16_bf16 v[48:63], v[216:219], v[224:227], v[48:63]
    v_exp_f32 v124, v124
    v_exp_f32 v125, v125
    v_exp_f32 v126, v126
    v_exp_f32 v127, v127
    v_cvt_pk_bf16_f32 v230, v124, v125
    v_cvt_pk_bf16_f32 v231, v126, v127
    v_mfma_f32_32x32x16_bf16 v[112:127], v[176:179], v[24:27], 0
    v_exp_f32 v128, v128
    v_exp_f32 v129, v129
    v_exp_f32 v130, v130
    v_exp_f32 v131, v131
    v_cvt_pk_bf16_f32 v224, v128, v129
    v_cvt_pk_bf16_f32 v225, v130, v131
    v_mfma_f32_32x32x16_bf16 v[112:127], v[180:183], v[28:31], v[112:127]
    v_exp_f32 v132, v132
    v_exp_f32 v133, v133
    v_exp_f32 v134, v134
    v_exp_f32 v135, v135
    v_cvt_pk_bf16_f32 v226, v132, v133
    v_cvt_pk_bf16_f32 v227, v134, v135
    v_mfma_f32_32x32x16_bf16 v[48:63], v[220:223], v[228:231], v[48:63]
    v_exp_f32 v136, v136
    v_exp_f32 v137, v137
    v_exp_f32 v138, v138
    v_exp_f32 v139, v139
    v_cvt_pk_bf16_f32 v228, v136, v137
    v_cvt_pk_bf16_f32 v229, v138, v139
    v_mfma_f32_32x32x16_bf16 v[48:63], v[152:155], v[224:227], v[48:63]
    v_exp_f32 v140, v140
    v_exp_f32 v141, v141
    v_exp_f32 v142, v142
    v_exp_f32 v143, v143
    v_cvt_pk_bf16_f32 v230, v140, v141
    v_cvt_pk_bf16_f32 v231, v142, v143
    v_mfma_f32_32x32x16_bf16 v[128:143], v[192:195], v[24:27], 0
    v_exp_f32 v112, v112
    v_exp_f32 v113, v113
    v_exp_f32 v114, v114
    v_exp_f32 v115, v115
    v_cvt_pk_bf16_f32 v224, v112, v113
    v_cvt_pk_bf16_f32 v225, v114, v115
    v_mfma_f32_32x32x16_bf16 v[128:143], v[196:199], v[28:31], v[128:143]
    v_exp_f32 v116, v116
    v_exp_f32 v117, v117
    v_exp_f32 v118, v118
    v_exp_f32 v119, v119
    v_cvt_pk_bf16_f32 v226, v116, v117
    v_cvt_pk_bf16_f32 v227, v118, v119
    v_mfma_f32_32x32x16_bf16 v[48:63], v[156:159], v[228:231], v[48:63]
    v_exp_f32 v120, v120
    v_exp_f32 v121, v121
    v_exp_f32 v122, v122
    v_exp_f32 v123, v123
    v_cvt_pk_bf16_f32 v228, v120, v121
    v_cvt_pk_bf16_f32 v229, v122, v123
    v_mfma_f32_32x32x16_bf16 v[64:79], v[184:187], v[224:227], v[64:79]
    v_exp_f32 v124, v124
    v_exp_f32 v125, v125
    v_exp_f32 v126, v126
    v_exp_f32 v127, v127
    v_cvt_pk_bf16_f32 v230, v124, v125
    v_cvt_pk_bf16_f32 v231, v126, v127
    v_mfma_f32_32x32x16_bf16 v[112:127], v[208:211], v[24:27], 0
    v_exp_f32 v128, v128
    v_exp_f32 v129, v129
    v_exp_f32 v130, v130
    v_exp_f32 v131, v131
    v_cvt_pk_bf16_f32 v224, v128, v129
    v_cvt_pk_bf16_f32 v225, v130, v131
    v_mfma_f32_32x32x16_bf16 v[112:127], v[212:215], v[28:31], v[112:127]
    ds_write_b128 v10, v[48:51] offset:0
    v_exp_f32 v132, v132
    v_exp_f32 v133, v133
    v_exp_f32 v134, v134
    v_exp_f32 v135, v135
    v_cvt_pk_bf16_f32 v226, v132, v133
    v_cvt_pk_bf16_f32 v227, v134, v135
    v_mfma_f32_32x32x16_bf16 v[64:79], v[188:191], v[228:231], v[64:79]
    v_exp_f32 v136, v136
    v_exp_f32 v137, v137
    v_exp_f32 v138, v138
    v_exp_f32 v139, v139
    v_cvt_pk_bf16_f32 v228, v136, v137
    v_cvt_pk_bf16_f32 v229, v138, v139
    v_mfma_f32_32x32x16_bf16 v[64:79], v[200:203], v[224:227], v[64:79]
    v_exp_f32 v140, v140
    v_exp_f32 v141, v141
    v_exp_f32 v142, v142
    v_exp_f32 v143, v143
    v_cvt_pk_bf16_f32 v230, v140, v141
    v_cvt_pk_bf16_f32 v231, v142, v143
    v_mfma_f32_32x32x16_bf16 v[128:143], v[144:147], v[24:27], 0
    v_exp_f32 v112, v112
    v_exp_f32 v113, v113
    v_exp_f32 v114, v114
    v_exp_f32 v115, v115
    v_cvt_pk_bf16_f32 v224, v112, v113
    v_cvt_pk_bf16_f32 v225, v114, v115
    v_mfma_f32_32x32x16_bf16 v[128:143], v[148:151], v[28:31], v[128:143]
    ds_write_b128 v10, v[52:55] offset:1024
    v_exp_f32 v116, v116
    v_exp_f32 v117, v117
    v_exp_f32 v118, v118
    v_exp_f32 v119, v119
    v_cvt_pk_bf16_f32 v226, v116, v117
    v_cvt_pk_bf16_f32 v227, v118, v119
    v_mfma_f32_32x32x16_bf16 v[64:79], v[204:207], v[228:231], v[64:79]
    v_exp_f32 v120, v120
    v_exp_f32 v121, v121
    v_exp_f32 v122, v122
    v_exp_f32 v123, v123
    v_cvt_pk_bf16_f32 v228, v120, v121
    v_cvt_pk_bf16_f32 v229, v122, v123
    v_mfma_f32_32x32x16_bf16 v[64:79], v[216:219], v[224:227], v[64:79]
    v_exp_f32 v124, v124
    v_exp_f32 v125, v125
    v_exp_f32 v126, v126
    v_exp_f32 v127, v127
    v_cvt_pk_bf16_f32 v230, v124, v125
    v_cvt_pk_bf16_f32 v231, v126, v127
    v_mfma_f32_32x32x16_bf16 v[112:127], v[176:179], v[32:35], 0
    v_exp_f32 v128, v128
    v_exp_f32 v129, v129
    v_exp_f32 v130, v130
    v_exp_f32 v131, v131
    v_cvt_pk_bf16_f32 v224, v128, v129
    v_cvt_pk_bf16_f32 v225, v130, v131
    v_mfma_f32_32x32x16_bf16 v[112:127], v[180:183], v[36:39], v[112:127]
    ds_write_b128 v10, v[56:59] offset:2048
    v_exp_f32 v132, v132
    v_exp_f32 v133, v133
    v_exp_f32 v134, v134
    v_exp_f32 v135, v135
    v_cvt_pk_bf16_f32 v226, v132, v133
    v_cvt_pk_bf16_f32 v227, v134, v135
    v_mfma_f32_32x32x16_bf16 v[64:79], v[220:223], v[228:231], v[64:79]
    v_exp_f32 v136, v136
    v_exp_f32 v137, v137
    v_exp_f32 v138, v138
    v_exp_f32 v139, v139
    v_cvt_pk_bf16_f32 v228, v136, v137
    v_cvt_pk_bf16_f32 v229, v138, v139
    v_mfma_f32_32x32x16_bf16 v[64:79], v[152:155], v[224:227], v[64:79]
    v_exp_f32 v140, v140
    v_exp_f32 v141, v141
    v_exp_f32 v142, v142
    v_exp_f32 v143, v143
    v_cvt_pk_bf16_f32 v230, v140, v141
    v_cvt_pk_bf16_f32 v231, v142, v143
    v_mfma_f32_32x32x16_bf16 v[128:143], v[192:195], v[32:35], 0
    s_setprio 3
    s_nop 0
    v_exp_f32 v112, v112
    v_exp_f32 v113, v113
    v_exp_f32 v114, v114
    v_exp_f32 v115, v115
    v_cvt_pk_bf16_f32 v224, v112, v113
    v_cvt_pk_bf16_f32 v225, v114, v115
    v_mfma_f32_32x32x16_bf16 v[128:143], v[196:199], v[36:39], v[128:143]
    ds_write_b128 v10, v[60:63] offset:3072
    v_exp_f32 v116, v116
    v_exp_f32 v117, v117
    v_exp_f32 v118, v118
    v_exp_f32 v119, v119
    v_cvt_pk_bf16_f32 v226, v116, v117
    v_cvt_pk_bf16_f32 v227, v118, v119
    v_mfma_f32_32x32x16_bf16 v[64:79], v[156:159], v[228:231], v[64:79]
    v_exp_f32 v120, v120
    v_exp_f32 v121, v121
    v_exp_f32 v122, v122
    v_exp_f32 v123, v123
    v_cvt_pk_bf16_f32 v228, v120, v121
    v_cvt_pk_bf16_f32 v229, v122, v123
    v_mfma_f32_32x32x16_bf16 v[80:95], v[184:187], v[224:227], v[80:95]
    v_exp_f32 v124, v124
    v_exp_f32 v125, v125
    v_exp_f32 v126, v126
    v_exp_f32 v127, v127
    v_cvt_pk_bf16_f32 v230, v124, v125
    v_cvt_pk_bf16_f32 v231, v126, v127
    v_mfma_f32_32x32x16_bf16 v[112:127], v[208:211], v[32:35], 0
    v_exp_f32 v128, v128
    v_exp_f32 v129, v129
    v_exp_f32 v130, v130
    v_exp_f32 v131, v131
    v_cvt_pk_bf16_f32 v224, v128, v129
    v_cvt_pk_bf16_f32 v225, v130, v131
    v_mfma_f32_32x32x16_bf16 v[112:127], v[212:215], v[36:39], v[112:127]
    ds_write_b128 v11, v[64:67] offset:0
    v_exp_f32 v132, v132
    v_exp_f32 v133, v133
    v_exp_f32 v134, v134
    v_exp_f32 v135, v135
    v_cvt_pk_bf16_f32 v226, v132, v133
    v_cvt_pk_bf16_f32 v227, v134, v135
    v_mfma_f32_32x32x16_bf16 v[80:95], v[188:191], v[228:231], v[80:95]
    v_exp_f32 v136, v136
    v_exp_f32 v137, v137
    v_exp_f32 v138, v138
    v_exp_f32 v139, v139
    v_cvt_pk_bf16_f32 v228, v136, v137
    v_cvt_pk_bf16_f32 v229, v138, v139
    v_mfma_f32_32x32x16_bf16 v[80:95], v[200:203], v[224:227], v[80:95]
    ds_write_b128 v11, v[68:71] offset:1024
    v_exp_f32 v140, v140
    v_exp_f32 v141, v141
    v_exp_f32 v142, v142
    v_exp_f32 v143, v143
    v_cvt_pk_bf16_f32 v230, v140, v141
    v_cvt_pk_bf16_f32 v231, v142, v143
    v_mfma_f32_32x32x16_bf16 v[128:143], v[144:147], v[32:35], 0
    v_exp_f32 v112, v112
    v_exp_f32 v113, v113
    v_exp_f32 v114, v114
    v_exp_f32 v115, v115
    v_cvt_pk_bf16_f32 v224, v112, v113
    v_cvt_pk_bf16_f32 v225, v114, v115
    v_mfma_f32_32x32x16_bf16 v[128:143], v[148:151], v[36:39], v[128:143]
    ds_write_b128 v11, v[72:75] offset:2048
    v_exp_f32 v116, v116
    v_exp_f32 v117, v117
    v_exp_f32 v118, v118
    v_exp_f32 v119, v119
    v_cvt_pk_bf16_f32 v226, v116, v117
    v_cvt_pk_bf16_f32 v227, v118, v119
    v_mfma_f32_32x32x16_bf16 v[80:95], v[204:207], v[228:231], v[80:95]
    v_exp_f32 v120, v120
    v_exp_f32 v121, v121
    v_exp_f32 v122, v122
    v_exp_f32 v123, v123
    v_cvt_pk_bf16_f32 v228, v120, v121
    v_cvt_pk_bf16_f32 v229, v122, v123
    v_mfma_f32_32x32x16_bf16 v[80:95], v[216:219], v[224:227], v[80:95]
    ds_write_b128 v11, v[76:79] offset:3072
    s_mov_b64 exec, 1
    ds_add_u32 v2, v3
    s_mov_b64 exec, -1
    v_exp_f32 v124, v124
    v_exp_f32 v125, v125
    v_exp_f32 v126, v126
    v_exp_f32 v127, v127
    v_cvt_pk_bf16_f32 v230, v124, v125
    v_cvt_pk_bf16_f32 v231, v126, v127
    v_mfma_f32_32x32x16_bf16 v[112:127], v[176:179], v[40:43], 0
    v_exp_f32 v128, v128
    v_exp_f32 v129, v129
    v_exp_f32 v130, v130
    v_exp_f32 v131, v131
    v_cvt_pk_bf16_f32 v224, v128, v129
    v_cvt_pk_bf16_f32 v225, v130, v131
    v_mfma_f32_32x32x16_bf16 v[112:127], v[180:183], v[44:47], v[112:127]
    v_exp_f32 v132, v132
    v_exp_f32 v133, v133
    v_exp_f32 v134, v134
    v_exp_f32 v135, v135
    v_cvt_pk_bf16_f32 v226, v132, v133
    v_cvt_pk_bf16_f32 v227, v134, v135
    v_mfma_f32_32x32x16_bf16 v[80:95], v[220:223], v[228:231], v[80:95]
    v_exp_f32 v136, v136
    v_exp_f32 v137, v137
    v_exp_f32 v138, v138
    v_exp_f32 v139, v139
    v_cvt_pk_bf16_f32 v228, v136, v137
    v_cvt_pk_bf16_f32 v229, v138, v139
    v_mfma_f32_32x32x16_bf16 v[80:95], v[152:155], v[224:227], v[80:95]
    v_exp_f32 v140, v140
    v_exp_f32 v141, v141
    v_exp_f32 v142, v142
    v_exp_f32 v143, v143
    v_cvt_pk_bf16_f32 v230, v140, v141
    v_cvt_pk_bf16_f32 v231, v142, v143
    v_mfma_f32_32x32x16_bf16 v[128:143], v[192:195], v[40:43], 0
    v_exp_f32 v112, v112
    v_exp_f32 v113, v113
    v_exp_f32 v114, v114
    v_exp_f32 v115, v115
    v_cvt_pk_bf16_f32 v224, v112, v113
    v_cvt_pk_bf16_f32 v225, v114, v115
    v_mfma_f32_32x32x16_bf16 v[128:143], v[196:199], v[44:47], v[128:143]
    ds_read_b32 v5, v2
    v_exp_f32 v116, v116
    v_exp_f32 v117, v117
    v_exp_f32 v118, v118
    v_exp_f32 v119, v119
    v_cvt_pk_bf16_f32 v226, v116, v117
    v_cvt_pk_bf16_f32 v227, v118, v119
    v_mfma_f32_32x32x16_bf16 v[80:95], v[156:159], v[228:231], v[80:95]
    v_exp_f32 v120, v120
    v_exp_f32 v121, v121
    v_exp_f32 v122, v122
    v_exp_f32 v123, v123
    v_cvt_pk_bf16_f32 v228, v120, v121
    v_cvt_pk_bf16_f32 v229, v122, v123
    v_mfma_f32_32x32x16_bf16 v[96:111], v[184:187], v[224:227], v[96:111]
    v_exp_f32 v124, v124
    v_exp_f32 v125, v125
    v_exp_f32 v126, v126
    v_exp_f32 v127, v127
    v_cvt_pk_bf16_f32 v230, v124, v125
    v_cvt_pk_bf16_f32 v231, v126, v127
    s_waitcnt lgkmcnt(0)
    v_readfirstlane_b32 s66, v5
    s_cmp_ge_u32 s66, 16
    s_cbranch_scc0 L_redw
L_redd:
    v_mfma_f32_32x32x16_bf16 v[112:127], v[208:211], v[40:43], 0
    ds_write_b128 v12, v[80:83] offset:0
    v_exp_f32 v128, v128
    v_exp_f32 v129, v129
    v_exp_f32 v130, v130
    v_exp_f32 v131, v131
    v_cvt_pk_bf16_f32 v224, v128, v129
    v_cvt_pk_bf16_f32 v225, v130, v131
    v_mfma_f32_32x32x16_bf16 v[112:127], v[212:215], v[44:47], v[112:127]
    ds_read_b128 v[48:51], v13 offset:0
    ds_read_b128 v[52:55], v13 offset:1024
    v_exp_f32 v132, v132
    v_exp_f32 v133, v133
    v_exp_f32 v134, v134
    v_exp_f32 v135, v135
    v_cvt_pk_bf16_f32 v226, v132, v133
    v_cvt_pk_bf16_f32 v227, v134, v135
    v_mfma_f32_32x32x16_bf16 v[96:111], v[188:191], v[228:231], v[96:111]
    ds_write_b128 v12, v[84:87] offset:1024
    v_exp_f32 v136, v136
    v_exp_f32 v137, v137
    v_exp_f32 v138, v138
    v_exp_f32 v139, v139
    v_cvt_pk_bf16_f32 v228, v136, v137
    v_cvt_pk_bf16_f32 v229, v138, v139
    v_mfma_f32_32x32x16_bf16 v[96:111], v[200:203], v[224:227], v[96:111]
    ds_read_b128 v[56:59], v13 offset:2048
    ds_read_b128 v[60:63], v13 offset:3072
    v_exp_f32 v140, v140
    v_exp_f32 v141, v141
    v_exp_f32 v142, v142
    v_exp_f32 v143, v143
    v_cvt_pk_bf16_f32 v230, v140, v141
    v_cvt_pk_bf16_f32 v231, v142, v143
    v_mfma_f32_32x32x16_bf16 v[128:143], v[144:147], v[40:43], 0
    ds_write_b128 v12, v[88:91] offset:2048
    v_exp_f32 v112, v112
    v_exp_f32 v113, v113
    v_exp_f32 v114, v114
    v_exp_f32 v115, v115
    v_cvt_pk_bf16_f32 v224, v112, v113
    v_cvt_pk_bf16_f32 v225, v114, v115
    v_mfma_f32_32x32x16_bf16 v[128:143], v[148:151], v[44:47], v[128:143]
    ds_read_b128 v[64:67], v13 offset:4096
    ds_read_b128 v[68:71], v13 offset:5120
    v_exp_f32 v116, v116
    v_exp_f32 v117, v117
    v_exp_f32 v118, v118
    v_exp_f32 v119, v119
    v_cvt_pk_bf16_f32 v226, v116, v117
    v_cvt_pk_bf16_f32 v227, v118, v119
    v_mfma_f32_32x32x16_bf16 v[96:111], v[204:207], v[228:231], v[96:111]
    ds_write_b128 v12, v[92:95] offset:3072
    s_mov_b64 exec, 1
    ds_add_u32 v2, v3
    s_mov_b64 exec, -1
    v_exp_f32 v120, v120
    v_exp_f32 v121, v121
    v_exp_f32 v122, v122
    v_exp_f32 v123, v123
    v_cvt_pk_bf16_f32 v228, v120, v121
    v_cvt_pk_bf16_f32 v229, v122, v123
    v_mfma_f32_32x32x16_bf16 v[96:111], v[216:219], v[224:227], v[96:111]
    ds_read_b128 v[72:75], v13 offset:6144
    ds_read_b128 v[76:79], v13 offset:7168
    v_exp_f32 v124, v124
    v_exp_f32 v125, v125
    v_exp_f32 v126, v126
    v_exp_f32 v127, v127
    v_cvt_pk_bf16_f32 v230, v124, v125
    v_cvt_pk_bf16_f32 v231, v126, v127
    v_exp_f32 v128, v128
    v_exp_f32 v129, v129
    v_exp_f32 v130, v130
    v_exp_f32 v131, v131
    v_cvt_pk_bf16_f32 v224, v128, v129
    v_cvt_pk_bf16_f32 v225, v130, v131
    v_exp_f32 v132, v132
    v_exp_f32 v133, v133
    v_exp_f32 v134, v134
    v_exp_f32 v135, v135
    v_cvt_pk_bf16_f32 v226, v132, v133
    v_cvt_pk_bf16_f32 v227, v134, v135
    v_mfma_f32_32x32x16_bf16 v[96:111], v[220:223], v[228:231], v[96:111]
    ds_read2_b32 v[4:5], v2 offset0:34 offset1:0
    v_exp_f32 v136, v136
    v_exp_f32 v137, v137
    v_exp_f32 v138, v138
    v_exp_f32 v139, v139
    v_cvt_pk_bf16_f32 v228, v136, v137
    v_cvt_pk_bf16_f32 v229, v138, v139
    v_mfma_f32_32x32x16_bf16 v[96:111], v[152:155], v[224:227], v[96:111]
    v_exp_f32 v140, v140
    v_exp_f32 v141, v141
    v_exp_f32 v142, v142
    v_exp_f32 v143, v143
    v_cvt_pk_bf16_f32 v230, v140, v141
    v_cvt_pk_bf16_f32 v231, v142, v143
    s_waitcnt lgkmcnt(0)
    v_readfirstlane_b32 s66, v5
    v_readfirstlane_b32 s67, v4
    v_mfma_f32_32x32x16_bf16 v[96:111], v[156:159], v[228:231], v[96:111]
    s_add_u32 s67, s67, 12
    s_min_u32 s66, s66, s67
    s_cmp_ge_u32 s66, 20
    s_cbranch_scc0 L_redw2
L_redd2:
    ds_read_b128 v[80:83], v13 offset:8192
    ds_read_b128 v[84:87], v13 offset:9216
    ds_read_b128 v[88:91], v13 offset:10240
    ds_read_b128 v[92:95], v13 offset:11264
    s_mov_b64 exec, 1
    ds_add_u32 v2, v3
    s_mov_b64 exec, s[76:77]
    buffer_store_dwordx2 v[244:245], v246, s[24:27], s11 offen sc1
    s_mov_b64 exec, -1
    v_add_f32 v48, v48, v64
    v_add_f32 v49, v49, v65
    v_add_f32 v50, v50, v66
    v_add_f32 v51, v51, v67
    v_add_f32 v52, v52, v68
    v_add_f32 v53, v53, v69
    v_add_f32 v54, v54, v70
    v_add_f32 v55, v55, v71
    v_add_f32 v56, v56, v72
    v_add_f32 v57, v57, v73
    v_add_f32 v58, v58, v74
    v_add_f32 v59, v59, v75
    v_add_f32 v60, v60, v76
    v_add_f32 v61, v61, v77
    v_add_f32 v62, v62, v78
    v_add_f32 v63, v63, v79
    v_add_f32 v96, v96, v48
    v_add_f32 v97, v97, v49
    v_add_f32 v98, v98, v50
    v_add_f32 v99, v99, v51
    v_add_f32 v100, v100, v52
    v_add_f32 v101, v101, v53
    v_add_f32 v102, v102, v54
    v_add_f32 v103, v103, v55
    v_add_f32 v104, v104, v56
    v_add_f32 v105, v105, v57
    v_add_f32 v106, v106, v58
    v_add_f32 v107, v107, v59
    v_add_f32 v108, v108, v60
    v_add_f32 v109, v109, v61
    v_add_f32 v110, v110, v62
    v_add_f32 v111, v111, v63
    s_waitcnt lgkmcnt(1)
    v_add_f32 v108, v108, v92
    v_add_f32 v109, v109, v93
    v_add_f32 v96, v96, v80
    v_add_f32 v97, v97, v81
    v_add_f32 v98, v98, v82
    v_add_f32 v99, v99, v83
    v_add_f32 v100, v100, v84
    v_add_f32 v101, v101, v85
    v_add_f32 v102, v102, v86
    v_add_f32 v103, v103, v87
    v_add_f32 v104, v104, v88
    v_add_f32 v105, v105, v89
    v_add_f32 v106, v106, v90
    v_add_f32 v107, v107, v91
    v_add_f32 v110, v110, v94
    v_add_f32 v111, v111, v95
    v_mov_b32 v10, v108
    v_mov_b32 v11, v108
    v_mul_f32 v12, v96, v97
    v_mul_f32 v13, v98, v99
    v_permlane32_swap_b32 v10, v11
    v_fma_f32 v12, v100, v101, v12
    v_fma_f32 v13, v102, v103, v13
    v_rcp_f32 v10, v11
    v_fma_f32 v12, v104, v105, v12
    v_fma_f32 v13, v106, v107, v13
    v_cmp_le_f32 s[70:71], s12, v11
    v_fma_f32 v12, v108, v109, v12
    v_fma_f32 v13, v110, v111, v13
    v_cmp_ge_f32 s[72:73], s13, v11
    v_add_f32 v12, v12, v13
    v_cmp_class_f32 vcc, v12, s14
    s_and_b64 s[70:71], s[70:71], s[72:73]
    s_and_b64 vcc, vcc, s[70:71]
    s_cmp_eq_u64 vcc, exec
    s_cbranch_scc0 L_fallback
L_fbdone:
    v_mov_b32 v11, v10
    s_nop 3
    v_mul_f32 v96, v96, v10
    v_mul_f32 v97, v97, v11
    v_mul_f32 v98, v98, v10
    v_mul_f32 v99, v99, v11
    v_mul_f32 v100, v100, v10
    v_mul_f32 v101, v101, v11
    v_mul_f32 v102, v102, v10
    v_mul_f32 v103, v103, v11
    v_cvt_pk_bf16_f32 v48, v96, v97
    v_cvt_pk_bf16_f32 v49, v98, v99
    v_cvt_pk_bf16_f32 v50, v100, v101
    v_cvt_pk_bf16_f32 v51, v102, v103
    v_min_u32 v48, -2, v48
    buffer_store_dwordx4 v[48:51], v7, s[24:27], s10 offen offset:0 sc1
    v_mul_f32 v104, v104, v10
    v_mul_f32 v105, v105, v11
    v_mul_f32 v106, v106, v10
    v_mul_f32 v107, v107, v11
    v_mul_f32 v108, v108, v10
    v_mul_f32 v109, v109, v11
    v_mul_f32 v110, v110, v10
    v_mul_f32 v111, v111, v11
    v_cvt_pk_bf16_f32 v52, v104, v105
    v_cvt_pk_bf16_f32 v53, v106, v107
    v_cvt_pk_bf16_f32 v54, v108, v109
    v_cvt_pk_bf16_f32 v55, v110, v111
    s_mov_b32 exec_lo, 0
    v_mov_b32 v54, 0
    s_mov_b32 exec_lo, -1
    v_min_u32 v52, -2, v52
    buffer_store_dwordx4 v[52:55], v7, s[24:27], s10 offen offset:1024 sc1
    s_lshl_b32 s70, s57, 3
    s_lshr_b32 s66, s58, 2
    s_add_u32 s70, s70, s66
    s_and_b32 s67, s58, 3
    s_cmp_ge_u32 s67, 2
    s_cselect_b32 s71, 3, 4
    s_lshl_b32 s72, s67, 2
    s_cmp_eq_u32 s67, 3
    s_cselect_b32 s72, 11, s72
    s_add_u32 s72, s72, s61
    s_cmp_ge_u32 s61, s71
    s_cbranch_scc1 L_bend
    s_setprio 0
    v_bfe_u32 v5, v1, 2, 1
    v_lshlrev_b32 v5, 4, v5
    v_bfe_u32 v6, v1, 3, 2
    v_lshl_add_u32 v5, v6, 2, v5
    v_and_b32 v6, 3, v1
    v_add_u32 v5, v5, v6
    s_lshl_b32 s66, s72, 5
    v_add_u32 v5, s66, v5
    v_lshlrev_b32 v9, 31, v5
    v_xor_b32 v9, 0.5, v9
    v_cvt_f32_u32 v5, v5
    v_mul_f32 v5, 0x3b124925, v5
    v_lshrrev_b32 v4, 5, v1
    v_cvt_f32_u32 v6, v4
    v_mul_f32 v6, v5, v6
    v_mul_f32 v6, 4.0, v6
    v_mul_f32 v176, 0x41800000, v5
    v_cos_f32 v176, v176
    v_fmamk_f32 v144, v5, 0x00000000, v6
    v_fmamk_f32 v145, v5, 0x3f800000, v6
    v_fmamk_f32 v146, v5, 0x40000000, v6
    v_fmamk_f32 v147, v5, 0x40400000, v6
    v_fmamk_f32 v148, v5, 0x41000000, v6
    v_fmamk_f32 v149, v5, 0x41100000, v6
    v_fmamk_f32 v150, v5, 0x41200000, v6
    v_fmamk_f32 v151, v5, 0x41300000, v6
    v_fmamk_f32 v152, v5, 0x41800000, v6
    v_fmamk_f32 v153, v5, 0x41880000, v6
    v_fmamk_f32 v154, v5, 0x41900000, v6
    v_fmamk_f32 v155, v5, 0x41980000, v6
    v_fmamk_f32 v156, v5, 0x41c00000, v6
    v_fmamk_f32 v157, v5, 0x41c80000, v6
    v_fmamk_f32 v158, v5, 0x41d00000, v6
    v_fmamk_f32 v159, v5, 0x41d80000, v6
    v_add_f32 v176, v176, v176
    v_sin_f32_e64 v160, -v144
    v_cos_f32 v144, v144
    v_sin_f32_e64 v161, -v145
    v_cos_f32 v145, v145
    v_sin_f32_e64 v162, -v146
    v_cos_f32 v146, v146
    v_sin_f32_e64 v163, -v147
    v_cos_f32 v147, v147
    v_sin_f32_e64 v164, -v148
    v_cos_f32 v148, v148
    v_sin_f32_e64 v165, -v149
    v_cos_f32 v149, v149
    v_sin_f32_e64 v166, -v150
    v_cos_f32 v150, v150
    v_sin_f32_e64 v167, -v151
    v_cos_f32 v151, v151
    v_sin_f32_e64 v168, -v152
    v_cos_f32 v152, v152
    v_sin_f32_e64 v169, -v153
    v_cos_f32 v153, v153
    v_sin_f32_e64 v170, -v154
    v_cos_f32 v154, v154
    v_sin_f32_e64 v171, -v155
    v_cos_f32 v155, v155
    v_sin_f32_e64 v172, -v156
    v_cos_f32 v156, v156
    v_sin_f32_e64 v173, -v157
    v_cos_f32 v157, v157
    v_sin_f32_e64 v174, -v158
    v_cos_f32 v158, v158
    v_sin_f32_e64 v175, -v159
    v_cos_f32 v159, v159
    v_mov_b32 v177, v176
.p2align 3
    v_cvt_pk_bf16_f32 v16, v144, v145
    v_cvt_pk_bf16_f32 v17, v146, v147
    v_cvt_pk_bf16_f32 v18, v148, v149
    v_cvt_pk_bf16_f32 v19, v150, v151
    s_mov_b32 exec_hi, 0
    v_cvt_pk_bf16_f32 v16, 0.5, v145
    s_mov_b32 exec_hi, -1
    v_cvt_pk_bf16_f32 v20, v160, v161
    v_cvt_pk_bf16_f32 v21, v162, v163
    v_cvt_pk_bf16_f32 v22, v164, v165
    v_cvt_pk_bf16_f32 v23, v166, v167
    s_mov_b32 exec_hi, 0
    v_cvt_pk_bf16_f32 v20, v9, v161
    s_mov_b32 exec_hi, -1
    v_cvt_pk_bf16_f32 v24, v152, v153
    v_cvt_pk_bf16_f32 v25, v154, v155
    v_cvt_pk_bf16_f32 v26, v156, v157
    v_cvt_pk_bf16_f32 v27, v158, v159
    v_cvt_pk_bf16_f32 v28, v168, v169
    v_cvt_pk_bf16_f32 v29, v170, v171
    v_cvt_pk_bf16_f32 v30, v172, v173
    v_cvt_pk_bf16_f32 v31, v174, v175
    v_pk_fma_f32 v[144:145], v[176:177], v[152:153], v[144:145] neg_lo:[0,0,1] neg_hi:[0,0,1]
    v_pk_fma_f32 v[146:147], v[176:177], v[154:155], v[146:147] neg_lo:[0,0,1] neg_hi:[0,0,1]
    v_pk_fma_f32 v[148:149], v[176:177], v[156:157], v[148:149] neg_lo:[0,0,1] neg_hi:[0,0,1]
    v_pk_fma_f32 v[150:151], v[176:177], v[158:159], v[150:151] neg_lo:[0,0,1] neg_hi:[0,0,1]
    v_cvt_pk_bf16_f32 v32, v144, v145
    v_cvt_pk_bf16_f32 v33, v146, v147
    v_cvt_pk_bf16_f32 v34, v148, v149
    v_cvt_pk_bf16_f32 v35, v150, v151
    v_pk_fma_f32 v[160:161], v[176:177], v[168:169], v[160:161] neg_lo:[0,0,1] neg_hi:[0,0,1]
    v_pk_fma_f32 v[162:163], v[176:177], v[170:171], v[162:163] neg_lo:[0,0,1] neg_hi:[0,0,1]
    v_pk_fma_f32 v[164:165], v[176:177], v[172:173], v[164:165] neg_lo:[0,0,1] neg_hi:[0,0,1]
    v_pk_fma_f32 v[166:167], v[176:177], v[174:175], v[166:167] neg_lo:[0,0,1] neg_hi:[0,0,1]
    v_cvt_pk_bf16_f32 v36, v160, v161
    v_cvt_pk_bf16_f32 v37, v162, v163
    v_cvt_pk_bf16_f32 v38, v164, v165
    v_cvt_pk_bf16_f32 v39, v166, v167
    v_pk_fma_f32 v[152:153], v[176:177], v[144:145], v[152:153] neg_lo:[0,0,1] neg_hi:[0,0,1]
    v_pk_fma_f32 v[154:155], v[176:177], v[146:147], v[154:155] neg_lo:[0,0,1] neg_hi:[0,0,1]
    v_pk_fma_f32 v[156:157], v[176:177], v[148:149], v[156:157] neg_lo:[0,0,1] neg_hi:[0,0,1]
    v_pk_fma_f32 v[158:159], v[176:177], v[150:151], v[158:159] neg_lo:[0,0,1] neg_hi:[0,0,1]
    v_cvt_pk_bf16_f32 v40, v152, v153
    v_cvt_pk_bf16_f32 v41, v154, v155
    v_cvt_pk_bf16_f32 v42, v156, v157
    v_cvt_pk_bf16_f32 v43, v158, v159
    v_pk_fma_f32 v[168:169], v[176:177], v[160:161], v[168:169] neg_lo:[0,0,1] neg_hi:[0,0,1]
    v_pk_fma_f32 v[170:171], v[176:177], v[162:163], v[170:171] neg_lo:[0,0,1] neg_hi:[0,0,1]
    v_pk_fma_f32 v[172:173], v[176:177], v[164:165], v[172:173] neg_lo:[0,0,1] neg_hi:[0,0,1]
    v_pk_fma_f32 v[174:175], v[176:177], v[166:167], v[174:175] neg_lo:[0,0,1] neg_hi:[0,0,1]
    v_cvt_pk_bf16_f32 v44, v168, v169
    v_cvt_pk_bf16_f32 v45, v170, v171
    v_cvt_pk_bf16_f32 v46, v172, v173
    v_cvt_pk_bf16_f32 v47, v174, v175
    v_pk_fma_f32 v[144:145], v[176:177], v[152:153], v[144:145] neg_lo:[0,0,1] neg_hi:[0,0,1]
    v_pk_fma_f32 v[146:147], v[176:177], v[154:155], v[146:147] neg_lo:[0,0,1] neg_hi:[0,0,1]
    v_pk_fma_f32 v[148:149], v[176:177], v[156:157], v[148:149] neg_lo:[0,0,1] neg_hi:[0,0,1]
    v_pk_fma_f32 v[150:151], v[176:177], v[158:159], v[150:151] neg_lo:[0,0,1] neg_hi:[0,0,1]
    v_cvt_pk_bf16_f32 v48, v144, v145
    v_cvt_pk_bf16_f32 v49, v146, v147
    v_cvt_pk_bf16_f32 v50, v148, v149
    v_cvt_pk_bf16_f32 v51, v150, v151
    v_pk_fma_f32 v[160:161], v[176:177], v[168:169], v[160:161] neg_lo:[0,0,1] neg_hi:[0,0,1]
    v_pk_fma_f32 v[162:163], v[176:177], v[170:171], v[162:163] neg_lo:[0,0,1] neg_hi:[0,0,1]
    v_pk_fma_f32 v[164:165], v[176:177], v[172:173], v[164:165] neg_lo:[0,0,1] neg_hi:[0,0,1]
    v_pk_fma_f32 v[166:167], v[176:177], v[174:175], v[166:167] neg_lo:[0,0,1] neg_hi:[0,0,1]
    v_cvt_pk_bf16_f32 v52, v160, v161
    v_cvt_pk_bf16_f32 v53, v162, v163
    v_cvt_pk_bf16_f32 v54, v164, v165
    v_cvt_pk_bf16_f32 v55, v166, v167
    v_pk_fma_f32 v[152:153], v[176:177], v[144:145], v[152:153] neg_lo:[0,0,1] neg_hi:[0,0,1]
    v_pk_fma_f32 v[154:155], v[176:177], v[146:147], v[154:155] neg_lo:[0,0,1] neg_hi:[0,0,1]
    v_pk_fma_f32 v[156:157], v[176:177], v[148:149], v[156:157] neg_lo:[0,0,1] neg_hi:[0,0,1]
    v_pk_fma_f32 v[158:159], v[176:177], v[150:151], v[158:159] neg_lo:[0,0,1] neg_hi:[0,0,1]
    v_cvt_pk_bf16_f32 v56, v152, v153
    v_cvt_pk_bf16_f32 v57, v154, v155
    v_cvt_pk_bf16_f32 v58, v156, v157
    v_cvt_pk_bf16_f32 v59, v158, v159
    v_pk_fma_f32 v[168:169], v[176:177], v[160:161], v[168:169] neg_lo:[0,0,1] neg_hi:[0,0,1]
    v_pk_fma_f32 v[170:171], v[176:177], v[162:163], v[170:171] neg_lo:[0,0,1] neg_hi:[0,0,1]
    v_pk_fma_f32 v[172:173], v[176:177], v[164:165], v[172:173] neg_lo:[0,0,1] neg_hi:[0,0,1]
    v_pk_fma_f32 v[174:175], v[176:177], v[166:167], v[174:175] neg_lo:[0,0,1] neg_hi:[0,0,1]
    v_cvt_pk_bf16_f32 v60, v168, v169
    v_cvt_pk_bf16_f32 v61, v170, v171
    v_cvt_pk_bf16_f32 v62, v172, v173
    v_cvt_pk_bf16_f32 v63, v174, v175
    v_pk_fma_f32 v[144:145], v[176:177], v[152:153], v[144:145] neg_lo:[0,0,1] neg_hi:[0,0,1]
    v_pk_fma_f32 v[146:147], v[176:177], v[154:155], v[146:147] neg_lo:[0,0,1] neg_hi:[0,0,1]
    v_pk_fma_f32 v[148:149], v[176:177], v[156:157], v[148:149] neg_lo:[0,0,1] neg_hi:[0,0,1]
    v_pk_fma_f32 v[150:151], v[176:177], v[158:159], v[150:151] neg_lo:[0,0,1] neg_hi:[0,0,1]
    v_cvt_pk_bf16_f32 v64, v144, v145
    v_cvt_pk_bf16_f32 v65, v146, v147
    v_cvt_pk_bf16_f32 v66, v148, v149
    v_cvt_pk_bf16_f32 v67, v150, v151
    v_pk_fma_f32 v[160:161], v[176:177], v[168:169], v[160:161] neg_lo:[0,0,1] neg_hi:[0,0,1]
    v_pk_fma_f32 v[162:163], v[176:177], v[170:171], v[162:163] neg_lo:[0,0,1] neg_hi:[0,0,1]
    v_pk_fma_f32 v[164:165], v[176:177], v[172:173], v[164:165] neg_lo:[0,0,1] neg_hi:[0,0,1]
    v_pk_fma_f32 v[166:167], v[176:177], v[174:175], v[166:167] neg_lo:[0,0,1] neg_hi:[0,0,1]
    v_cvt_pk_bf16_f32 v68, v160, v161
    v_cvt_pk_bf16_f32 v69, v162, v163
    v_cvt_pk_bf16_f32 v70, v164, v165
    v_cvt_pk_bf16_f32 v71, v166, v167
    v_pk_fma_f32 v[152:153], v[176:177], v[144:145], v[152:153] neg_lo:[0,0,1] neg_hi:[0,0,1]
    v_pk_fma_f32 v[154:155], v[176:177], v[146:147], v[154:155] neg_lo:[0,0,1] neg_hi:[0,0,1]
    v_pk_fma_f32 v[156:157], v[176:177], v[148:149], v[156:157] neg_lo:[0,0,1] neg_hi:[0,0,1]
    v_pk_fma_f32 v[158:159], v[176:177], v[150:151], v[158:159] neg_lo:[0,0,1] neg_hi:[0,0,1]
    v_cvt_pk_bf16_f32 v72, v152, v153
    v_cvt_pk_bf16_f32 v73, v154, v155
    v_cvt_pk_bf16_f32 v74, v156, v157
    v_cvt_pk_bf16_f32 v75, v158, v159
    v_pk_fma_f32 v[168:169], v[176:177], v[160:161], v[168:169] neg_lo:[0,0,1] neg_hi:[0,0,1]
    v_pk_fma_f32 v[170:171], v[176:177], v[162:163], v[170:171] neg_lo:[0,0,1] neg_hi:[0,0,1]
    v_pk_fma_f32 v[172:173], v[176:177], v[164:165], v[172:173] neg_lo:[0,0,1] neg_hi:[0,0,1]
    v_pk_fma_f32 v[174:175], v[176:177], v[166:167], v[174:175] neg_lo:[0,0,1] neg_hi:[0,0,1]
    v_cvt_pk_bf16_f32 v76, v168, v169
    v_cvt_pk_bf16_f32 v77, v170, v171
    v_cvt_pk_bf16_f32 v78, v172, v173
    v_cvt_pk_bf16_f32 v79, v174, v175
    v_pk_fma_f32 v[144:145], v[176:177], v[152:153], v[144:145] neg_lo:[0,0,1] neg_hi:[0,0,1]
    v_pk_fma_f32 v[146:147], v[176:177], v[154:155], v[146:147] neg_lo:[0,0,1] neg_hi:[0,0,1]
    v_pk_fma_f32 v[148:149], v[176:177], v[156:157], v[148:149] neg_lo:[0,0,1] neg_hi:[0,0,1]
    v_pk_fma_f32 v[150:151], v[176:177], v[158:159], v[150:151] neg_lo:[0,0,1] neg_hi:[0,0,1]
    v_cvt_pk_bf16_f32 v80, v144, v145
    v_cvt_pk_bf16_f32 v81, v146, v147
    v_cvt_pk_bf16_f32 v82, v148, v149
    v_cvt_pk_bf16_f32 v83, v150, v151
    v_pk_fma_f32 v[160:161], v[176:177], v[168:169], v[160:161] neg_lo:[0,0,1] neg_hi:[0,0,1]
    v_pk_fma_f32 v[162:163], v[176:177], v[170:171], v[162:163] neg_lo:[0,0,1] neg_hi:[0,0,1]
    v_pk_fma_f32 v[164:165], v[176:177], v[172:173], v[164:165] neg_lo:[0,0,1] neg_hi:[0,0,1]
    v_pk_fma_f32 v[166:167], v[176:177], v[174:175], v[166:167] neg_lo:[0,0,1] neg_hi:[0,0,1]
    v_cvt_pk_bf16_f32 v84, v160, v161
    v_cvt_pk_bf16_f32 v85, v162, v163
    v_cvt_pk_bf16_f32 v86, v164, v165
    v_cvt_pk_bf16_f32 v87, v166, v167
    v_pk_fma_f32 v[152:153], v[176:177], v[144:145], v[152:153] neg_lo:[0,0,1] neg_hi:[0,0,1]
    v_pk_fma_f32 v[154:155], v[176:177], v[146:147], v[154:155] neg_lo:[0,0,1] neg_hi:[0,0,1]
    v_pk_fma_f32 v[156:157], v[176:177], v[148:149], v[156:157] neg_lo:[0,0,1] neg_hi:[0,0,1]
    v_pk_fma_f32 v[158:159], v[176:177], v[150:151], v[158:159] neg_lo:[0,0,1] neg_hi:[0,0,1]
    v_cvt_pk_bf16_f32 v88, v152, v153
    v_cvt_pk_bf16_f32 v89, v154, v155
    v_cvt_pk_bf16_f32 v90, v156, v157
    v_cvt_pk_bf16_f32 v91, v158, v159
    v_pk_fma_f32 v[168:169], v[176:177], v[160:161], v[168:169] neg_lo:[0,0,1] neg_hi:[0,0,1]
    v_pk_fma_f32 v[170:171], v[176:177], v[162:163], v[170:171] neg_lo:[0,0,1] neg_hi:[0,0,1]
    v_pk_fma_f32 v[172:173], v[176:177], v[164:165], v[172:173] neg_lo:[0,0,1] neg_hi:[0,0,1]
    v_pk_fma_f32 v[174:175], v[176:177], v[166:167], v[174:175] neg_lo:[0,0,1] neg_hi:[0,0,1]
    v_cvt_pk_bf16_f32 v92, v168, v169
    v_cvt_pk_bf16_f32 v93, v170, v171
    v_cvt_pk_bf16_f32 v94, v172, v173
    v_cvt_pk_bf16_f32 v95, v174, v175
    v_pk_fma_f32 v[144:145], v[176:177], v[152:153], v[144:145] neg_lo:[0,0,1] neg_hi:[0,0,1]
    v_pk_fma_f32 v[146:147], v[176:177], v[154:155], v[146:147] neg_lo:[0,0,1] neg_hi:[0,0,1]
    v_pk_fma_f32 v[148:149], v[176:177], v[156:157], v[148:149] neg_lo:[0,0,1] neg_hi:[0,0,1]
    v_pk_fma_f32 v[150:151], v[176:177], v[158:159], v[150:151] neg_lo:[0,0,1] neg_hi:[0,0,1]
    v_cvt_pk_bf16_f32 v96, v144, v145
    v_cvt_pk_bf16_f32 v97, v146, v147
    v_cvt_pk_bf16_f32 v98, v148, v149
    v_cvt_pk_bf16_f32 v99, v150, v151
    v_pk_fma_f32 v[160:161], v[176:177], v[168:169], v[160:161] neg_lo:[0,0,1] neg_hi:[0,0,1]
    v_pk_fma_f32 v[162:163], v[176:177], v[170:171], v[162:163] neg_lo:[0,0,1] neg_hi:[0,0,1]
    v_pk_fma_f32 v[164:165], v[176:177], v[172:173], v[164:165] neg_lo:[0,0,1] neg_hi:[0,0,1]
    v_pk_fma_f32 v[166:167], v[176:177], v[174:175], v[166:167] neg_lo:[0,0,1] neg_hi:[0,0,1]
    v_cvt_pk_bf16_f32 v100, v160, v161
    v_cvt_pk_bf16_f32 v101, v162, v163
    v_cvt_pk_bf16_f32 v102, v164, v165
    v_cvt_pk_bf16_f32 v103, v166, v167
    v_pk_fma_f32 v[152:153], v[176:177], v[144:145], v[152:153] neg_lo:[0,0,1] neg_hi:[0,0,1]
    v_pk_fma_f32 v[154:155], v[176:177], v[146:147], v[154:155] neg_lo:[0,0,1] neg_hi:[0,0,1]
    v_pk_fma_f32 v[156:157], v[176:177], v[148:149], v[156:157] neg_lo:[0,0,1] neg_hi:[0,0,1]
    v_pk_fma_f32 v[158:159], v[176:177], v[150:151], v[158:159] neg_lo:[0,0,1] neg_hi:[0,0,1]
    v_cvt_pk_bf16_f32 v104, v152, v153
    v_cvt_pk_bf16_f32 v105, v154, v155
    v_cvt_pk_bf16_f32 v106, v156, v157
    v_cvt_pk_bf16_f32 v107, v158, v159
    v_pk_fma_f32 v[168:169], v[176:177], v[160:161], v[168:169] neg_lo:[0,0,1] neg_hi:[0,0,1]
    v_pk_fma_f32 v[170:171], v[176:177], v[162:163], v[170:171] neg_lo:[0,0,1] neg_hi:[0,0,1]
    v_pk_fma_f32 v[172:173], v[176:177], v[164:165], v[172:173] neg_lo:[0,0,1] neg_hi:[0,0,1]
    v_pk_fma_f32 v[174:175], v[176:177], v[166:167], v[174:175] neg_lo:[0,0,1] neg_hi:[0,0,1]
    v_cvt_pk_bf16_f32 v108, v168, v169
    v_cvt_pk_bf16_f32 v109, v170, v171
    v_cvt_pk_bf16_f32 v110, v172, v173
    v_cvt_pk_bf16_f32 v111, v174, v175
    v_pk_fma_f32 v[144:145], v[176:177], v[152:153], v[144:145] neg_lo:[0,0,1] neg_hi:[0,0,1]
    v_pk_fma_f32 v[146:147], v[176:177], v[154:155], v[146:147] neg_lo:[0,0,1] neg_hi:[0,0,1]
    v_pk_fma_f32 v[148:149], v[176:177], v[156:157], v[148:149] neg_lo:[0,0,1] neg_hi:[0,0,1]
    v_pk_fma_f32 v[150:151], v[176:177], v[158:159], v[150:151] neg_lo:[0,0,1] neg_hi:[0,0,1]
    v_cvt_pk_bf16_f32 v112, v144, v145
    v_cvt_pk_bf16_f32 v113, v146, v147
    v_cvt_pk_bf16_f32 v114, v148, v149
    v_cvt_pk_bf16_f32 v115, v150, v151
    v_pk_fma_f32 v[160:161], v[176:177], v[168:169], v[160:161] neg_lo:[0,0,1] neg_hi:[0,0,1]
    v_pk_fma_f32 v[162:163], v[176:177], v[170:171], v[162:163] neg_lo:[0,0,1] neg_hi:[0,0,1]
    v_pk_fma_f32 v[164:165], v[176:177], v[172:173], v[164:165] neg_lo:[0,0,1] neg_hi:[0,0,1]
    v_pk_fma_f32 v[166:167], v[176:177], v[174:175], v[166:167] neg_lo:[0,0,1] neg_hi:[0,0,1]
    v_cvt_pk_bf16_f32 v116, v160, v161
    v_cvt_pk_bf16_f32 v117, v162, v163
    v_cvt_pk_bf16_f32 v118, v164, v165
    v_cvt_pk_bf16_f32 v119, v166, v167
    v_pk_fma_f32 v[152:153], v[176:177], v[144:145], v[152:153] neg_lo:[0,0,1] neg_hi:[0,0,1]
    v_pk_fma_f32 v[154:155], v[176:177], v[146:147], v[154:155] neg_lo:[0,0,1] neg_hi:[0,0,1]
    v_pk_fma_f32 v[156:157], v[176:177], v[148:149], v[156:157] neg_lo:[0,0,1] neg_hi:[0,0,1]
    v_pk_fma_f32 v[158:159], v[176:177], v[150:151], v[158:159] neg_lo:[0,0,1] neg_hi:[0,0,1]
    v_cvt_pk_bf16_f32 v120, v152, v153
    v_cvt_pk_bf16_f32 v121, v154, v155
    v_cvt_pk_bf16_f32 v122, v156, v157
    v_cvt_pk_bf16_f32 v123, v158, v159
    v_pk_fma_f32 v[168:169], v[176:177], v[160:161], v[168:169] neg_lo:[0,0,1] neg_hi:[0,0,1]
    v_pk_fma_f32 v[170:171], v[176:177], v[162:163], v[170:171] neg_lo:[0,0,1] neg_hi:[0,0,1]
    v_pk_fma_f32 v[172:173], v[176:177], v[164:165], v[172:173] neg_lo:[0,0,1] neg_hi:[0,0,1]
    v_pk_fma_f32 v[174:175], v[176:177], v[166:167], v[174:175] neg_lo:[0,0,1] neg_hi:[0,0,1]
    v_cvt_pk_bf16_f32 v124, v168, v169
    v_cvt_pk_bf16_f32 v125, v170, v171
    v_cvt_pk_bf16_f32 v126, v172, v173
    v_cvt_pk_bf16_f32 v127, v174, v175
    s_mov_b32 s48, s16
    s_mov_b32 s49, s17
    s_mov_b32 s50, 3670016
    s_mov_b32 s51, 0x20000
    v_add_u32 v8, 57344, v7
    s_mul_i32 s22, s70, 1792
    s_lshl_b32 s67, s72, 6
    s_add_u32 s22, s22, s67
    s_lshl_b32 s67, s61, 11
    s_add_u32 s67, s67, 151552
    v_and_b32 v10, 31, v1
    v_lshlrev_b32 v10, 6, v10
    v_lshl_add_u32 v10, v4, 5, v10
    v_add_u32 v10, s67, v10
    v_add_u32 v11, s67, v7
    v_lshrrev_b32 v6, 2, v1
    v_mul_u32_u24 v6, 114688, v6
    v_and_b32 v12, 3, v1
    v_lshl_add_u32 v6, v12, 4, v6
    s_add_u32 s69, s22, 1835008
    s_mov_b32 s64, 1048576
L_lw_14:
    ds_read_b32 v5, v2 offset:132
    s_waitcnt lgkmcnt(0)
    v_readfirstlane_b32 s66, v5
    s_cmp_ge_u32 s66, 4
    s_cbranch_scc1 L_lwd_15
    s_sub_u32 s64, s64, 1
    s_cbranch_scc0 L_lw_14
    s_mov_b32 s64, 17
    s_branch L_fail
L_lwd_15:
    ds_read_b128 v[196:199], v8 offset:0
    ds_read_b128 v[200:203], v8 offset:2048
    ds_read_b128 v[204:207], v8 offset:1024
    ds_read_b128 v[208:211], v8 offset:3072
    ds_read_b128 v[212:215], v8 offset:4096
    ds_read_b128 v[216:219], v8 offset:6144
    ds_read_b128 v[220:223], v8 offset:5120
    ds_read_b128 v[224:227], v8 offset:7168
    s_waitcnt lgkmcnt(7)
    v_mfma_f32_32x32x16_bf16 v[128:143], v[16:19], v[196:199], 0
    ds_read_b128 v[196:199], v8 offset:8192
    s_waitcnt lgkmcnt(7)
    v_mfma_f32_32x32x16_bf16 v[128:143], v[20:23], v[200:203], v[128:143]
    ds_read_b128 v[200:203], v8 offset:10240
    s_waitcnt lgkmcnt(7)
    v_mfma_f32_32x32x16_bf16 v[128:143], v[24:27], v[204:207], v[128:143]
    ds_read_b128 v[204:207], v8 offset:9216
    s_waitcnt lgkmcnt(7)
    v_mfma_f32_32x32x16_bf16 v[128:143], v[28:31], v[208:211], v[128:143]
    ds_read_b128 v[208:211], v8 offset:11264
    s_waitcnt lgkmcnt(7)
    v_mfma_f32_32x32x16_bf16 v[128:143], v[32:35], v[212:215], v[128:143]
    ds_read_b128 v[212:215], v8 offset:12288
    s_waitcnt lgkmcnt(7)
    v_mfma_f32_32x32x16_bf16 v[128:143], v[36:39], v[216:219], v[128:143]
    ds_read_b128 v[216:219], v8 offset:14336
    s_waitcnt lgkmcnt(7)
    v_mfma_f32_32x32x16_bf16 v[128:143], v[40:43], v[220:223], v[128:143]
    ds_read_b128 v[220:223], v8 offset:13312
    s_waitcnt lgkmcnt(7)
    v_mfma_f32_32x32x16_bf16 v[128:143], v[44:47], v[224:227], v[128:143]
    ds_read_b128 v[224:227], v8 offset:15360
    s_waitcnt lgkmcnt(7)
    v_mfma_f32_32x32x16_bf16 v[128:143], v[48:51], v[196:199], v[128:143]
    ds_read_b128 v[196:199], v8 offset:16384
    s_waitcnt lgkmcnt(7)
    v_mfma_f32_32x32x16_bf16 v[128:143], v[52:55], v[200:203], v[128:143]
    ds_read_b128 v[200:203], v8 offset:18432
    s_waitcnt lgkmcnt(7)
    v_mfma_f32_32x32x16_bf16 v[128:143], v[56:59], v[204:207], v[128:143]
    ds_read_b128 v[204:207], v8 offset:17408
    s_waitcnt lgkmcnt(7)
    v_mfma_f32_32x32x16_bf16 v[128:143], v[60:63], v[208:211], v[128:143]
    ds_read_b128 v[208:211], v8 offset:19456
    s_waitcnt lgkmcnt(7)
    v_mfma_f32_32x32x16_bf16 v[128:143], v[64:67], v[212:215], v[128:143]
    ds_read_b128 v[212:215], v8 offset:20480
    s_waitcnt lgkmcnt(7)
    v_mfma_f32_32x32x16_bf16 v[128:143], v[68:71], v[216:219], v[128:143]
    ds_read_b128 v[216:219], v8 offset:22528
    s_waitcnt lgkmcnt(7)
    v_mfma_f32_32x32x16_bf16 v[128:143], v[72:75], v[220:223], v[128:143]
    ds_read_b128 v[220:223], v8 offset:21504
    s_waitcnt lgkmcnt(7)
    v_mfma_f32_32x32x16_bf16 v[128:143], v[76:79], v[224:227], v[128:143]
    ds_read_b128 v[224:227], v8 offset:23552
    s_waitcnt lgkmcnt(7)
    v_mfma_f32_32x32x16_bf16 v[128:143], v[80:83], v[196:199], v[128:143]
    ds_read_b128 v[196:199], v8 offset:24576
    s_waitcnt lgkmcnt(7)
    v_mfma_f32_32x32x16_bf16 v[128:143], v[84:87], v[200:203], v[128:143]
    ds_read_b128 v[200:203], v8 offset:26624
    s_waitcnt lgkmcnt(7)
    v_mfma_f32_32x32x16_bf16 v[128:143], v[88:91], v[204:207], v[128:143]
    ds_read_b128 v[204:207], v8 offset:25600
    s_waitcnt lgkmcnt(7)
    v_mfma_f32_32x32x16_bf16 v[128:143], v[92:95], v[208:211], v[128:143]
    ds_read_b128 v[208:211], v8 offset:27648
    s_waitcnt lgkmcnt(7)
    v_mfma_f32_32x32x16_bf16 v[128:143], v[96:99], v[212:215], v[128:143]
    s_waitcnt lgkmcnt(6)
    v_mfma_f32_32x32x16_bf16 v[128:143], v[100:103], v[216:219], v[128:143]
    s_waitcnt lgkmcnt(5)
    v_mfma_f32_32x32x16_bf16 v[128:143], v[104:107], v[220:223], v[128:143]
    s_waitcnt lgkmcnt(4)
    v_mfma_f32_32x32x16_bf16 v[128:143], v[108:111], v[224:227], v[128:143]
    s_waitcnt lgkmcnt(3)
    v_mfma_f32_32x32x16_bf16 v[128:143], v[112:115], v[196:199], v[128:143]
    s_waitcnt lgkmcnt(2)
    v_mfma_f32_32x32x16_bf16 v[128:143], v[116:119], v[200:203], v[128:143]
    s_waitcnt lgkmcnt(1)
    v_mfma_f32_32x32x16_bf16 v[128:143], v[120:123], v[204:207], v[128:143]
    s_waitcnt lgkmcnt(0)
    v_mfma_f32_32x32x16_bf16 v[128:143], v[124:127], v[208:211], v[128:143]
    s_nop 11
    v_cvt_pk_bf16_f32 v144, v128, v129
    v_cvt_pk_bf16_f32 v145, v130, v131
    v_cvt_pk_bf16_f32 v146, v132, v133
    v_cvt_pk_bf16_f32 v147, v134, v135
    ds_write_b128 v10, v[144:147] offset:0
    v_cvt_pk_bf16_f32 v148, v136, v137
    v_cvt_pk_bf16_f32 v149, v138, v139
    v_cvt_pk_bf16_f32 v150, v140, v141
    v_cvt_pk_bf16_f32 v151, v142, v143
    ds_write_b128 v10, v[148:151] offset:16
    ds_read_b128 v[152:155], v11
    ds_read_b128 v[156:159], v11 offset:1024
    s_waitcnt lgkmcnt(1)
    buffer_store_dwordx4 v[152:155], v6, s[48:51], s22 offen sc0 sc1
    s_waitcnt lgkmcnt(0)
    buffer_store_dwordx4 v[156:159], v6, s[48:51], s69 offen sc0 sc1
L_bend:
    s_endpgm
L_redw:
    s_mov_b32 s64, 1048576
L_lw_16:
    ds_read_b32 v5, v2 offset:0
    s_waitcnt lgkmcnt(0)
    v_readfirstlane_b32 s66, v5
    s_cmp_ge_u32 s66, 16
    s_cbranch_scc1 L_lwd_17
    s_sub_u32 s64, s64, 1
    s_cbranch_scc0 L_lw_16
    s_mov_b32 s64, 2
    s_branch L_fail
L_lwd_17:
    s_branch L_redd
L_redw2:
    s_mov_b32 s64, 1048576
L_lw_18:
    ds_read_b32 v5, v2 offset:0
    s_waitcnt lgkmcnt(0)
    v_readfirstlane_b32 s66, v5
    s_cmp_ge_u32 s66, 20
    s_cbranch_scc1 L_lwd_19
    s_sub_u32 s64, s64, 1
    s_cbranch_scc0 L_lw_18
    s_mov_b32 s64, 2
    s_branch L_fail
L_lwd_19:
    s_mov_b32 s64, 1048576
L_lw_20:
    ds_read_b32 v5, v2 offset:136
    s_waitcnt lgkmcnt(0)
    v_readfirstlane_b32 s66, v5
    s_cmp_ge_u32 s66, 8
    s_cbranch_scc1 L_lwd_21
    s_sleep 1
    s_sub_u32 s64, s64, 1
    s_cbranch_scc0 L_lw_20
    s_mov_b32 s64, 39
    s_branch L_fail
L_lwd_21:
    s_branch L_redd2
L_gate1:
    s_mov_b32 s64, 131072
L_poll_22:
    v_mov_b32 v14, 0
    v_mov_b32 v15, 0
    s_mov_b64 exec, s[0:1]
    buffer_atomic_or_x2 v[14:15], v242, s[24:27], s5 offen sc0 sc1
    s_mov_b64 exec, -1
    s_waitcnt vmcnt(0)
    v_cmp_ne_u64 vcc, s[62:63], v[14:15]
    s_and_b64 vcc, vcc, s[0:1]
    s_cbranch_scc0 L_polld_23
    s_sleep 2
    s_sub_u32 s64, s64, 1
    s_cbranch_scc0 L_poll_22
    s_mov_b32 s64, 25
    s_branch L_fail
L_polld_23:
    s_branch L_gated1
L_gate2:
    s_mov_b32 s64, 131072
L_poll_24:
    v_mov_b32 v14, 0
    v_mov_b32 v15, 0
    s_mov_b64 exec, s[0:1]
    buffer_atomic_or_x2 v[14:15], v242, s[24:27], s6 offen sc0 sc1
    s_mov_b64 exec, -1
    s_waitcnt vmcnt(0)
    v_cmp_ne_u64 vcc, s[62:63], v[14:15]
    s_and_b64 vcc, vcc, s[0:1]
    s_cbranch_scc0 L_polld_25
    s_sleep 2
    s_sub_u32 s64, s64, 1
    s_cbranch_scc0 L_poll_24
    s_mov_b32 s64, 25
    s_branch L_fail
L_polld_25:
    s_branch L_gated2
L_gate3:
    s_mov_b32 s64, 131072
L_poll_26:
    v_mov_b32 v14, 0
    v_mov_b32 v15, 0
    s_mov_b64 exec, s[0:1]
    buffer_atomic_or_x2 v[14:15], v242, s[24:27], s7 offen sc0 sc1
    s_mov_b64 exec, -1
    s_waitcnt vmcnt(0)
    v_cmp_ne_u64 vcc, s[62:63], v[14:15]
    s_and_b64 vcc, vcc, s[0:1]
    s_cbranch_scc0 L_polld_27
    s_sleep 2
    s_sub_u32 s64, s64, 1
    s_cbranch_scc0 L_poll_26
    s_mov_b32 s64, 25
    s_branch L_fail
L_polld_27:
    s_branch L_gated3
L_fallback:
    v_mov_b32 v15, 0xff800000
    s_mov_b32 s70, 786432
L_fb1:
    buffer_load_dwordx4 v[144:147], v240, s[24:27], s70 offen offset:0 sc1
    buffer_load_dwordx4 v[148:151], v240, s[24:27], s70 offen offset:1024 sc1
    s_add_u32 s70, s70, 61440
    s_waitcnt vmcnt(0)
    v_mfma_f32_32x32x16_bf16 v[112:127], v[144:147], v[40:43], 0
    v_mfma_f32_32x32x16_bf16 v[112:127], v[148:151], v[44:47], v[112:127]
    s_nop 11
    v_max3_f32 v15, v15, v112, v113
    v_max3_f32 v15, v15, v114, v115
    v_max3_f32 v15, v15, v116, v117
    v_max3_f32 v15, v15, v118, v119
    v_max3_f32 v15, v15, v120, v121
    v_max3_f32 v15, v15, v122, v123
    v_max3_f32 v15, v15, v124, v125
    v_max3_f32 v15, v15, v126, v127
    s_cmp_lt_u32 s70, 4718592
    s_cbranch_scc1 L_fb1
    v_mov_b32 v14, v15
    s_nop 1
    v_permlane32_swap_b32 v14, v15
    v_max_f32 v15, v14, v15
    s_mov_b32 s70, 786432
    v_mov_b32 v96, 0
    v_mov_b32 v97, 0
    v_mov_b32 v98, 0
    v_mov_b32 v99, 0
    v_mov_b32 v100, 0
    v_mov_b32 v101, 0
    v_mov_b32 v102, 0
    v_mov_b32 v103, 0
    v_mov_b32 v104, 0
    v_mov_b32 v105, 0
    v_mov_b32 v106, 0
    v_mov_b32 v107, 0
    v_mov_b32 v108, 0
    v_mov_b32 v109, 0
    v_mov_b32 v110, 0
    v_mov_b32 v111, 0
L_fb2:
    buffer_load_dwordx4 v[144:147], v240, s[24:27], s70 offen offset:0 sc1
    buffer_load_dwordx4 v[148:151], v240, s[24:27], s70 offen offset:1024 sc1
    buffer_load_dwordx4 v[152:155], v241, s[24:27], s70 offen offset:0 sc1
    buffer_load_dwordx4 v[156:159], v241, s[24:27], s70 offen offset:1024 sc1
    s_add_u32 s70, s70, 61440
    s_waitcnt vmcnt(0)
    v_mfma_f32_32x32x16_bf16 v[112:127], v[144:147], v[40:43], 0
    v_mfma_f32_32x32x16_bf16 v[112:127], v[148:151], v[44:47], v[112:127]
    s_nop 11
    v_sub_f32 v112, v112, v15
    v_sub_f32 v113, v113, v15
    v_sub_f32 v114, v114, v15
    v_sub_f32 v115, v115, v15
    v_sub_f32 v116, v116, v15
    v_sub_f32 v117, v117, v15
    v_sub_f32 v118, v118, v15
    v_sub_f32 v119, v119, v15
    v_sub_f32 v120, v120, v15
    v_sub_f32 v121, v121, v15
    v_sub_f32 v122, v122, v15
    v_sub_f32 v123, v123, v15
    v_sub_f32 v124, v124, v15
    v_sub_f32 v125, v125, v15
    v_sub_f32 v126, v126, v15
    v_sub_f32 v127, v127, v15
    v_exp_f32 v112, v112
    v_exp_f32 v113, v113
    v_exp_f32 v114, v114
    v_exp_f32 v115, v115
    v_exp_f32 v116, v116
    v_exp_f32 v117, v117
    v_exp_f32 v118, v118
    v_exp_f32 v119, v119
    v_exp_f32 v120, v120
    v_exp_f32 v121, v121
    v_exp_f32 v122, v122
    v_exp_f32 v123, v123
    v_exp_f32 v124, v124
    v_exp_f32 v125, v125
    v_exp_f32 v126, v126
    v_exp_f32 v127, v127
    v_cvt_pk_bf16_f32 v224, v112, v113
    v_cvt_pk_bf16_f32 v225, v114, v115
    v_cvt_pk_bf16_f32 v226, v116, v117
    v_cvt_pk_bf16_f32 v227, v118, v119
    v_cvt_pk_bf16_f32 v228, v120, v121
    v_cvt_pk_bf16_f32 v229, v122, v123
    v_cvt_pk_bf16_f32 v230, v124, v125
    v_cvt_pk_bf16_f32 v231, v126, v127
    v_mfma_f32_32x32x16_bf16 v[96:111], v[152:155], v[224:227], v[96:111]
    s_nop 0
    v_mfma_f32_32x32x16_bf16 v[96:111], v[156:159], v[228:231], v[96:111]
    s_cmp_lt_u32 s70, 4718592
    s_cbranch_scc1 L_fb2
    s_nop 9
    v_mov_b32 v10, v108
    v_mov_b32 v11, v108
    s_nop 1
    v_permlane32_swap_b32 v10, v11
    v_rcp_f32 v10, v11
    s_branch L_fbdone
L_roleA:
    v_mov_b32 v3, 0
    v_mov_b32 v2, 159744
    ds_write2_b32 v2, v3, v3 offset0:0 offset1:32
    ds_write2_b32 v2, v3, v3 offset0:1 offset1:2
    ds_write2_b32 v2, v3, v3 offset0:3 offset1:33
    ds_write2_b32 v2, v3, v3 offset0:4 offset1:34
    ds_write2_b32 v2, v3, v3 offset0:5 offset1:35
    ds_write2_b32 v2, v3, v3 offset0:8 offset1:9
    ds_write2_b32 v2, v3, v3 offset0:10 offset1:11
    s_setprio 2
    s_mov_b32 s65, 0
    s_lshl_b32 s78, s57, 3
    s_lshr_b32 s66, s58, 2
    s_add_u32 s78, s78, s66
    s_and_b32 s79, s58, 3
    s_cmp_ge_u32 s79, 2
    s_cselect_b32 s80, 3, 4
    s_lshl_b32 s81, s79, 2
    s_cmp_eq_u32 s79, 3
    s_cselect_b32 s81, 11, s81
    s_add_u32 s82, s81, s61
    v_and_b32 v2, 31, v1
    v_lshrrev_b32 v3, 5, v1
    v_cvt_f32_u32 v4, v3
    s_waitcnt lgkmcnt(0)
    v_and_b32 v5, 15, v1
    s_lshl_b32 s66, s82, 4
    v_add_u32 v5, s66, v5
    v_bfe_u32 v6, v1, 4, 1
    v_lshl_add_u32 v7, v5, 1, v6
    v_cmp_eq_u32 vcc, 1, v7
    v_mov_b32 v7, 224
    s_nop 0
    v_cndmask_b32 v5, v5, v7, vcc
    v_cndmask_b32 v6, v6, 0, vcc
    v_cvt_f32_u32 v5, v5
    v_cvt_f32_u32 v6, v6
    v_mul_f32 v5, 0x3b124925, v5
    v_mul_f32 v6, 0x3e800000, v6
    v_mul_f32 v7, v5, v4
    v_fmamk_f32 v6, v7, 0x41000000, v6
    v_mul_f32 v232, 0x41800000, v5
    v_cos_f32 v232, v232
    v_fmamk_f32 v216, v5, 0x00000000, v6
    v_fmamk_f32 v217, v5, 0x3f800000, v6
    v_fmamk_f32 v218, v5, 0x40000000, v6
    v_fmamk_f32 v219, v5, 0x40400000, v6
    v_fmamk_f32 v220, v5, 0x40800000, v6
    v_fmamk_f32 v221, v5, 0x40a00000, v6
    v_fmamk_f32 v222, v5, 0x40c00000, v6
    v_fmamk_f32 v223, v5, 0x40e00000, v6
    v_fmamk_f32 v224, v5, 0x41800000, v6
    v_fmamk_f32 v225, v5, 0x41880000, v6
    v_fmamk_f32 v226, v5, 0x41900000, v6
    v_fmamk_f32 v227, v5, 0x41980000, v6
    v_fmamk_f32 v228, v5, 0x41a00000, v6
    v_fmamk_f32 v229, v5, 0x41a80000, v6
    v_fmamk_f32 v230, v5, 0x41b00000, v6
    v_fmamk_f32 v231, v5, 0x41b80000, v6
    v_add_f32 v232, v232, v232
    v_cos_f32 v216, v216
    v_cos_f32 v217, v217
    v_cos_f32 v218, v218
    v_cos_f32 v219, v219
    v_cos_f32 v220, v220
    v_cos_f32 v221, v221
    v_cos_f32 v222, v222
    v_cos_f32 v223, v223
    v_cos_f32 v224, v224
    v_cos_f32 v225, v225
    v_cos_f32 v226, v226
    v_cos_f32 v227, v227
    v_cos_f32 v228, v228
    v_cos_f32 v229, v229
    v_cos_f32 v230, v230
    v_cos_f32 v231, v231
    v_mov_b32 v233, v232
    s_barrier
.p2align 3
    v_cvt_pk_bf16_f32 v88, v216, v217
    v_cvt_pk_bf16_f32 v89, v218, v219
    v_cvt_pk_bf16_f32 v90, v220, v221
    v_cvt_pk_bf16_f32 v91, v222, v223
    v_cvt_pk_bf16_f32 v92, v224, v225
    v_cvt_pk_bf16_f32 v93, v226, v227
    v_cvt_pk_bf16_f32 v94, v228, v229
    v_cvt_pk_bf16_f32 v95, v230, v231
    v_pk_fma_f32 v[216:217], v[232:233], v[224:225], v[216:217] neg_lo:[0,0,1] neg_hi:[0,0,1]
    v_pk_fma_f32 v[218:219], v[232:233], v[226:227], v[218:219] neg_lo:[0,0,1] neg_hi:[0,0,1]
    v_pk_fma_f32 v[220:221], v[232:233], v[228:229], v[220:221] neg_lo:[0,0,1] neg_hi:[0,0,1]
    v_pk_fma_f32 v[222:223], v[232:233], v[230:231], v[222:223] neg_lo:[0,0,1] neg_hi:[0,0,1]
    v_cvt_pk_bf16_f32 v96, v216, v217
    v_cvt_pk_bf16_f32 v97, v218, v219
    v_cvt_pk_bf16_f32 v98, v220, v221
    v_cvt_pk_bf16_f32 v99, v222, v223
    v_pk_fma_f32 v[224:225], v[232:233], v[216:217], v[224:225] neg_lo:[0,0,1] neg_hi:[0,0,1]
    v_pk_fma_f32 v[226:227], v[232:233], v[218:219], v[226:227] neg_lo:[0,0,1] neg_hi:[0,0,1]
    v_pk_fma_f32 v[228:229], v[232:233], v[220:221], v[228:229] neg_lo:[0,0,1] neg_hi:[0,0,1]
    v_pk_fma_f32 v[230:231], v[232:233], v[222:223], v[230:231] neg_lo:[0,0,1] neg_hi:[0,0,1]
    v_cvt_pk_bf16_f32 v100, v224, v225
    v_cvt_pk_bf16_f32 v101, v226, v227
    v_cvt_pk_bf16_f32 v102, v228, v229
    v_cvt_pk_bf16_f32 v103, v230, v231
    v_pk_fma_f32 v[216:217], v[232:233], v[224:225], v[216:217] neg_lo:[0,0,1] neg_hi:[0,0,1]
    v_pk_fma_f32 v[218:219], v[232:233], v[226:227], v[218:219] neg_lo:[0,0,1] neg_hi:[0,0,1]
    v_pk_fma_f32 v[220:221], v[232:233], v[228:229], v[220:221] neg_lo:[0,0,1] neg_hi:[0,0,1]
    v_pk_fma_f32 v[222:223], v[232:233], v[230:231], v[222:223] neg_lo:[0,0,1] neg_hi:[0,0,1]
    v_cvt_pk_bf16_f32 v104, v216, v217
    v_cvt_pk_bf16_f32 v105, v218, v219
    v_cvt_pk_bf16_f32 v106, v220, v221
    v_cvt_pk_bf16_f32 v107, v222, v223
    v_pk_fma_f32 v[224:225], v[232:233], v[216:217], v[224:225] neg_lo:[0,0,1] neg_hi:[0,0,1]
    v_pk_fma_f32 v[226:227], v[232:233], v[218:219], v[226:227] neg_lo:[0,0,1] neg_hi:[0,0,1]
    v_pk_fma_f32 v[228:229], v[232:233], v[220:221], v[228:229] neg_lo:[0,0,1] neg_hi:[0,0,1]
    v_pk_fma_f32 v[230:231], v[232:233], v[222:223], v[230:231] neg_lo:[0,0,1] neg_hi:[0,0,1]
    v_cvt_pk_bf16_f32 v108, v224, v225
    v_cvt_pk_bf16_f32 v109, v226, v227
    v_cvt_pk_bf16_f32 v110, v228, v229
    v_cvt_pk_bf16_f32 v111, v230, v231
    v_pk_fma_f32 v[216:217], v[232:233], v[224:225], v[216:217] neg_lo:[0,0,1] neg_hi:[0,0,1]
    v_pk_fma_f32 v[218:219], v[232:233], v[226:227], v[218:219] neg_lo:[0,0,1] neg_hi:[0,0,1]
    v_pk_fma_f32 v[220:221], v[232:233], v[228:229], v[220:221] neg_lo:[0,0,1] neg_hi:[0,0,1]
    v_pk_fma_f32 v[222:223], v[232:233], v[230:231], v[222:223] neg_lo:[0,0,1] neg_hi:[0,0,1]
    v_cvt_pk_bf16_f32 v112, v216, v217
    v_cvt_pk_bf16_f32 v113, v218, v219
    v_cvt_pk_bf16_f32 v114, v220, v221
    v_cvt_pk_bf16_f32 v115, v222, v223
    v_pk_fma_f32 v[224:225], v[232:233], v[216:217], v[224:225] neg_lo:[0,0,1] neg_hi:[0,0,1]
    v_pk_fma_f32 v[226:227], v[232:233], v[218:219], v[226:227] neg_lo:[0,0,1] neg_hi:[0,0,1]
    v_pk_fma_f32 v[228:229], v[232:233], v[220:221], v[228:229] neg_lo:[0,0,1] neg_hi:[0,0,1]
    v_pk_fma_f32 v[230:231], v[232:233], v[222:223], v[230:231] neg_lo:[0,0,1] neg_hi:[0,0,1]
    v_cvt_pk_bf16_f32 v116, v224, v225
    v_cvt_pk_bf16_f32 v117, v226, v227
    v_cvt_pk_bf16_f32 v118, v228, v229
    v_cvt_pk_bf16_f32 v119, v230, v231
    v_pk_fma_f32 v[216:217], v[232:233], v[224:225], v[216:217] neg_lo:[0,0,1] neg_hi:[0,0,1]
    v_pk_fma_f32 v[218:219], v[232:233], v[226:227], v[218:219] neg_lo:[0,0,1] neg_hi:[0,0,1]
    v_pk_fma_f32 v[220:221], v[232:233], v[228:229], v[220:221] neg_lo:[0,0,1] neg_hi:[0,0,1]
    v_pk_fma_f32 v[222:223], v[232:233], v[230:231], v[222:223] neg_lo:[0,0,1] neg_hi:[0,0,1]
    v_cvt_pk_bf16_f32 v120, v216, v217
    v_cvt_pk_bf16_f32 v121, v218, v219
    v_cvt_pk_bf16_f32 v122, v220, v221
    v_cvt_pk_bf16_f32 v123, v222, v223
    v_pk_fma_f32 v[224:225], v[232:233], v[216:217], v[224:225] neg_lo:[0,0,1] neg_hi:[0,0,1]
    v_pk_fma_f32 v[226:227], v[232:233], v[218:219], v[226:227] neg_lo:[0,0,1] neg_hi:[0,0,1]
    v_pk_fma_f32 v[228:229], v[232:233], v[220:221], v[228:229] neg_lo:[0,0,1] neg_hi:[0,0,1]
    v_pk_fma_f32 v[230:231], v[232:233], v[222:223], v[230:231] neg_lo:[0,0,1] neg_hi:[0,0,1]
    v_cvt_pk_bf16_f32 v124, v224, v225
    v_cvt_pk_bf16_f32 v125, v226, v227
    v_cvt_pk_bf16_f32 v126, v228, v229
    v_cvt_pk_bf16_f32 v127, v230, v231
    v_pk_fma_f32 v[216:217], v[232:233], v[224:225], v[216:217] neg_lo:[0,0,1] neg_hi:[0,0,1]
    v_pk_fma_f32 v[218:219], v[232:233], v[226:227], v[218:219] neg_lo:[0,0,1] neg_hi:[0,0,1]
    v_pk_fma_f32 v[220:221], v[232:233], v[228:229], v[220:221] neg_lo:[0,0,1] neg_hi:[0,0,1]
    v_pk_fma_f32 v[222:223], v[232:233], v[230:231], v[222:223] neg_lo:[0,0,1] neg_hi:[0,0,1]
    v_cvt_pk_bf16_f32 v128, v216, v217
    v_cvt_pk_bf16_f32 v129, v218, v219
    v_cvt_pk_bf16_f32 v130, v220, v221
    v_cvt_pk_bf16_f32 v131, v222, v223
    v_pk_fma_f32 v[224:225], v[232:233], v[216:217], v[224:225] neg_lo:[0,0,1] neg_hi:[0,0,1]
    v_pk_fma_f32 v[226:227], v[232:233], v[218:219], v[226:227] neg_lo:[0,0,1] neg_hi:[0,0,1]
    v_pk_fma_f32 v[228:229], v[232:233], v[220:221], v[228:229] neg_lo:[0,0,1] neg_hi:[0,0,1]
    v_pk_fma_f32 v[230:231], v[232:233], v[222:223], v[230:231] neg_lo:[0,0,1] neg_hi:[0,0,1]
    v_cvt_pk_bf16_f32 v132, v224, v225
    v_cvt_pk_bf16_f32 v133, v226, v227
    v_cvt_pk_bf16_f32 v134, v228, v229
    v_cvt_pk_bf16_f32 v135, v230, v231
    v_pk_fma_f32 v[216:217], v[232:233], v[224:225], v[216:217] neg_lo:[0,0,1] neg_hi:[0,0,1]
    v_pk_fma_f32 v[218:219], v[232:233], v[226:227], v[218:219] neg_lo:[0,0,1] neg_hi:[0,0,1]
    v_pk_fma_f32 v[220:221], v[232:233], v[228:229], v[220:221] neg_lo:[0,0,1] neg_hi:[0,0,1]
    v_pk_fma_f32 v[222:223], v[232:233], v[230:231], v[222:223] neg_lo:[0,0,1] neg_hi:[0,0,1]
    v_cvt_pk_bf16_f32 v136, v216, v217
    v_cvt_pk_bf16_f32 v137, v218, v219
    v_cvt_pk_bf16_f32 v138, v220, v221
    v_cvt_pk_bf16_f32 v139, v222, v223
    v_pk_fma_f32 v[224:225], v[232:233], v[216:217], v[224:225] neg_lo:[0,0,1] neg_hi:[0,0,1]
    v_pk_fma_f32 v[226:227], v[232:233], v[218:219], v[226:227] neg_lo:[0,0,1] neg_hi:[0,0,1]
    v_pk_fma_f32 v[228:229], v[232:233], v[220:221], v[228:229] neg_lo:[0,0,1] neg_hi:[0,0,1]
    v_pk_fma_f32 v[230:231], v[232:233], v[222:223], v[230:231] neg_lo:[0,0,1] neg_hi:[0,0,1]
    v_cvt_pk_bf16_f32 v140, v224, v225
    v_cvt_pk_bf16_f32 v141, v226, v227
    v_cvt_pk_bf16_f32 v142, v228, v229
    v_cvt_pk_bf16_f32 v143, v230, v231
    v_pk_fma_f32 v[216:217], v[232:233], v[224:225], v[216:217] neg_lo:[0,0,1] neg_hi:[0,0,1]
    v_pk_fma_f32 v[218:219], v[232:233], v[226:227], v[218:219] neg_lo:[0,0,1] neg_hi:[0,0,1]
    v_pk_fma_f32 v[220:221], v[232:233], v[228:229], v[220:221] neg_lo:[0,0,1] neg_hi:[0,0,1]
    v_pk_fma_f32 v[222:223], v[232:233], v[230:231], v[222:223] neg_lo:[0,0,1] neg_hi:[0,0,1]
    v_cvt_pk_bf16_f32 v144, v216, v217
    v_cvt_pk_bf16_f32 v145, v218, v219
    v_cvt_pk_bf16_f32 v146, v220, v221
    v_cvt_pk_bf16_f32 v147, v222, v223
    v_pk_fma_f32 v[224:225], v[232:233], v[216:217], v[224:225] neg_lo:[0,0,1] neg_hi:[0,0,1]
    v_pk_fma_f32 v[226:227], v[232:233], v[218:219], v[226:227] neg_lo:[0,0,1] neg_hi:[0,0,1]
    v_pk_fma_f32 v[228:229], v[232:233], v[220:221], v[228:229] neg_lo:[0,0,1] neg_hi:[0,0,1]
    v_pk_fma_f32 v[230:231], v[232:233], v[222:223], v[230:231] neg_lo:[0,0,1] neg_hi:[0,0,1]
    v_cvt_pk_bf16_f32 v148, v224, v225
    v_cvt_pk_bf16_f32 v149, v226, v227
    v_cvt_pk_bf16_f32 v150, v228, v229
    v_cvt_pk_bf16_f32 v151, v230, v231
    v_pk_fma_f32 v[216:217], v[232:233], v[224:225], v[216:217] neg_lo:[0,0,1] neg_hi:[0,0,1]
    v_pk_fma_f32 v[218:219], v[232:233], v[226:227], v[218:219] neg_lo:[0,0,1] neg_hi:[0,0,1]
    v_pk_fma_f32 v[220:221], v[232:233], v[228:229], v[220:221] neg_lo:[0,0,1] neg_hi:[0,0,1]
    v_pk_fma_f32 v[222:223], v[232:233], v[230:231], v[222:223] neg_lo:[0,0,1] neg_hi:[0,0,1]
    v_cvt_pk_bf16_f32 v152, v216, v217
    v_cvt_pk_bf16_f32 v153, v218, v219
    v_cvt_pk_bf16_f32 v154, v220, v221
    v_cvt_pk_bf16_f32 v155, v222, v223
    v_pk_fma_f32 v[224:225], v[232:233], v[216:217], v[224:225] neg_lo:[0,0,1] neg_hi:[0,0,1]
    v_pk_fma_f32 v[226:227], v[232:233], v[218:219], v[226:227] neg_lo:[0,0,1] neg_hi:[0,0,1]
    v_pk_fma_f32 v[228:229], v[232:233], v[220:221], v[228:229] neg_lo:[0,0,1] neg_hi:[0,0,1]
    v_pk_fma_f32 v[230:231], v[232:233], v[222:223], v[230:231] neg_lo:[0,0,1] neg_hi:[0,0,1]
    v_cvt_pk_bf16_f32 v156, v224, v225
    v_cvt_pk_bf16_f32 v157, v226, v227
    v_cvt_pk_bf16_f32 v158, v228, v229
    v_cvt_pk_bf16_f32 v159, v230, v231
    v_pk_fma_f32 v[216:217], v[232:233], v[224:225], v[216:217] neg_lo:[0,0,1] neg_hi:[0,0,1]
    v_pk_fma_f32 v[218:219], v[232:233], v[226:227], v[218:219] neg_lo:[0,0,1] neg_hi:[0,0,1]
    v_pk_fma_f32 v[220:221], v[232:233], v[228:229], v[220:221] neg_lo:[0,0,1] neg_hi:[0,0,1]
    v_pk_fma_f32 v[222:223], v[232:233], v[230:231], v[222:223] neg_lo:[0,0,1] neg_hi:[0,0,1]
    v_cvt_pk_bf16_f32 v160, v216, v217
    v_cvt_pk_bf16_f32 v161, v218, v219
    v_cvt_pk_bf16_f32 v162, v220, v221
    v_cvt_pk_bf16_f32 v163, v222, v223
    v_pk_fma_f32 v[224:225], v[232:233], v[216:217], v[224:225] neg_lo:[0,0,1] neg_hi:[0,0,1]
    v_pk_fma_f32 v[226:227], v[232:233], v[218:219], v[226:227] neg_lo:[0,0,1] neg_hi:[0,0,1]
    v_pk_fma_f32 v[228:229], v[232:233], v[220:221], v[228:229] neg_lo:[0,0,1] neg_hi:[0,0,1]
    v_pk_fma_f32 v[230:231], v[232:233], v[222:223], v[230:231] neg_lo:[0,0,1] neg_hi:[0,0,1]
    v_cvt_pk_bf16_f32 v164, v224, v225
    v_cvt_pk_bf16_f32 v165, v226, v227
    v_cvt_pk_bf16_f32 v166, v228, v229
    v_cvt_pk_bf16_f32 v167, v230, v231
    v_pk_fma_f32 v[216:217], v[232:233], v[224:225], v[216:217] neg_lo:[0,0,1] neg_hi:[0,0,1]
    v_pk_fma_f32 v[218:219], v[232:233], v[226:227], v[218:219] neg_lo:[0,0,1] neg_hi:[0,0,1]
    v_pk_fma_f32 v[220:221], v[232:233], v[228:229], v[220:221] neg_lo:[0,0,1] neg_hi:[0,0,1]
    v_pk_fma_f32 v[222:223], v[232:233], v[230:231], v[222:223] neg_lo:[0,0,1] neg_hi:[0,0,1]
    v_cvt_pk_bf16_f32 v168, v216, v217
    v_cvt_pk_bf16_f32 v169, v218, v219
    v_cvt_pk_bf16_f32 v170, v220, v221
    v_cvt_pk_bf16_f32 v171, v222, v223
    v_pk_fma_f32 v[224:225], v[232:233], v[216:217], v[224:225] neg_lo:[0,0,1] neg_hi:[0,0,1]
    v_pk_fma_f32 v[226:227], v[232:233], v[218:219], v[226:227] neg_lo:[0,0,1] neg_hi:[0,0,1]
    v_pk_fma_f32 v[228:229], v[232:233], v[220:221], v[228:229] neg_lo:[0,0,1] neg_hi:[0,0,1]
    v_pk_fma_f32 v[230:231], v[232:233], v[222:223], v[230:231] neg_lo:[0,0,1] neg_hi:[0,0,1]
    v_cvt_pk_bf16_f32 v172, v224, v225
    v_cvt_pk_bf16_f32 v173, v226, v227
    v_cvt_pk_bf16_f32 v174, v228, v229
    v_cvt_pk_bf16_f32 v175, v230, v231
    v_pk_fma_f32 v[216:217], v[232:233], v[224:225], v[216:217] neg_lo:[0,0,1] neg_hi:[0,0,1]
    v_pk_fma_f32 v[218:219], v[232:233], v[226:227], v[218:219] neg_lo:[0,0,1] neg_hi:[0,0,1]
    v_pk_fma_f32 v[220:221], v[232:233], v[228:229], v[220:221] neg_lo:[0,0,1] neg_hi:[0,0,1]
    v_pk_fma_f32 v[222:223], v[232:233], v[230:231], v[222:223] neg_lo:[0,0,1] neg_hi:[0,0,1]
    v_cvt_pk_bf16_f32 v176, v216, v217
    v_cvt_pk_bf16_f32 v177, v218, v219
    v_cvt_pk_bf16_f32 v178, v220, v221
    v_cvt_pk_bf16_f32 v179, v222, v223
    v_pk_fma_f32 v[224:225], v[232:233], v[216:217], v[224:225] neg_lo:[0,0,1] neg_hi:[0,0,1]
    v_pk_fma_f32 v[226:227], v[232:233], v[218:219], v[226:227] neg_lo:[0,0,1] neg_hi:[0,0,1]
    v_pk_fma_f32 v[228:229], v[232:233], v[220:221], v[228:229] neg_lo:[0,0,1] neg_hi:[0,0,1]
    v_pk_fma_f32 v[230:231], v[232:233], v[222:223], v[230:231] neg_lo:[0,0,1] neg_hi:[0,0,1]
    v_cvt_pk_bf16_f32 v180, v224, v225
    v_cvt_pk_bf16_f32 v181, v226, v227
    v_cvt_pk_bf16_f32 v182, v228, v229
    v_cvt_pk_bf16_f32 v183, v230, v231
    v_pk_fma_f32 v[216:217], v[232:233], v[224:225], v[216:217] neg_lo:[0,0,1] neg_hi:[0,0,1]
    v_pk_fma_f32 v[218:219], v[232:233], v[226:227], v[218:219] neg_lo:[0,0,1] neg_hi:[0,0,1]
    v_pk_fma_f32 v[220:221], v[232:233], v[228:229], v[220:221] neg_lo:[0,0,1] neg_hi:[0,0,1]
    v_pk_fma_f32 v[222:223], v[232:233], v[230:231], v[222:223] neg_lo:[0,0,1] neg_hi:[0,0,1]
    v_cvt_pk_bf16_f32 v184, v216, v217
    v_cvt_pk_bf16_f32 v185, v218, v219
    v_cvt_pk_bf16_f32 v186, v220, v221
    v_cvt_pk_bf16_f32 v187, v222, v223
    v_pk_fma_f32 v[224:225], v[232:233], v[216:217], v[224:225] neg_lo:[0,0,1] neg_hi:[0,0,1]
    v_pk_fma_f32 v[226:227], v[232:233], v[218:219], v[226:227] neg_lo:[0,0,1] neg_hi:[0,0,1]
    v_pk_fma_f32 v[228:229], v[232:233], v[220:221], v[228:229] neg_lo:[0,0,1] neg_hi:[0,0,1]
    v_pk_fma_f32 v[230:231], v[232:233], v[222:223], v[230:231] neg_lo:[0,0,1] neg_hi:[0,0,1]
    v_cvt_pk_bf16_f32 v188, v224, v225
    v_cvt_pk_bf16_f32 v189, v226, v227
    v_cvt_pk_bf16_f32 v190, v228, v229
    v_cvt_pk_bf16_f32 v191, v230, v231
    v_pk_fma_f32 v[216:217], v[232:233], v[224:225], v[216:217] neg_lo:[0,0,1] neg_hi:[0,0,1]
    v_pk_fma_f32 v[218:219], v[232:233], v[226:227], v[218:219] neg_lo:[0,0,1] neg_hi:[0,0,1]
    v_pk_fma_f32 v[220:221], v[232:233], v[228:229], v[220:221] neg_lo:[0,0,1] neg_hi:[0,0,1]
    v_pk_fma_f32 v[222:223], v[232:233], v[230:231], v[222:223] neg_lo:[0,0,1] neg_hi:[0,0,1]
    v_cvt_pk_bf16_f32 v192, v216, v217
    v_cvt_pk_bf16_f32 v193, v218, v219
    v_cvt_pk_bf16_f32 v194, v220, v221
    v_cvt_pk_bf16_f32 v195, v222, v223
    v_pk_fma_f32 v[224:225], v[232:233], v[216:217], v[224:225] neg_lo:[0,0,1] neg_hi:[0,0,1]
    v_pk_fma_f32 v[226:227], v[232:233], v[218:219], v[226:227] neg_lo:[0,0,1] neg_hi:[0,0,1]
    v_pk_fma_f32 v[228:229], v[232:233], v[220:221], v[228:229] neg_lo:[0,0,1] neg_hi:[0,0,1]
    v_pk_fma_f32 v[230:231], v[232:233], v[222:223], v[230:231] neg_lo:[0,0,1] neg_hi:[0,0,1]
    v_cvt_pk_bf16_f32 v196, v224, v225
    v_cvt_pk_bf16_f32 v197, v226, v227
    v_cvt_pk_bf16_f32 v198, v228, v229
    v_cvt_pk_bf16_f32 v199, v230, v231
    s_mov_b32 s28, s12
    s_mov_b32 s29, s13
    s_mov_b32 s30, 1204224
    s_mov_b32 s31, 0x20000
    s_mov_b32 s32, s4
    s_mov_b32 s33, s5
    s_mov_b32 s34, 1835008
    s_mov_b32 s35, 0x20000
    s_mov_b32 s36, s6
    s_mov_b32 s37, s7
    s_mov_b32 s38, 921600
    s_mov_b32 s39, 0x20000
    s_mov_b32 s40, s8
    s_mov_b32 s41, s9
    s_mov_b32 s42, 921600
    s_mov_b32 s43, 0x20000
    s_mov_b32 s44, s14
    s_mov_b32 s45, s15
    s_mov_b32 s46, 401408
    s_mov_b32 s47, 0x20000
    s_lshl_b32 s66, s60, 4
    s_add_u32 s66, s66, s59
    s_lshl_b32 s66, s66, 2
    s_add_u32 s66, s66, s61
    s_cmp_lg_u32 s66, 24
    s_cbranch_scc1 L_noinit
    s_load_dwordx2 s[62:63], s[20:21], 0
    s_mov_b32 s24, s20
    s_mov_b32 s25, s21
    s_mov_b32 s26, 16777216
    s_mov_b32 s27, 0x20000
    s_waitcnt lgkmcnt(0)
    s_mul_i32 s62, s62, 0x9E3779B1
    s_add_u32 s62, s62, 0x7F4A7C15
    s_mul_i32 s63, s63, 0x85EBCA6D
    s_add_u32 s63, s63, 0x165667B1
    v_mov_b32 v8, s62
    v_mov_b32 v9, s63
    v_mov_b32 v10, s62
    v_mov_b32 v11, s63
    v_lshlrev_b32 v12, 4, v1
    s_mov_b32 s66, 4096
    buffer_store_dwordx4 v[8:11], v12, s[24:27], s66 offen sc1
    s_mov_b32 s66, 8192
    buffer_store_dwordx4 v[8:11], v12, s[24:27], s66 offen sc1
    s_mov_b32 s66, 9216
    buffer_store_dwordx4 v[8:11], v12, s[24:27], s66 offen sc1
    s_mov_b32 s66, 10240
    buffer_store_dwordx4 v[8:11], v12, s[24:27], s66 offen sc1
    s_mov_b32 s66, 11264
    buffer_store_dwordx4 v[8:11], v12, s[24:27], s66 offen sc1
    s_mov_b32 s66, 12288
    buffer_store_dwordx4 v[8:11], v12, s[24:27], s66 offen sc1
    s_mov_b32 s66, 13312
    buffer_store_dwordx4 v[8:11], v12, s[24:27], s66 offen sc1
    s_mov_b32 s66, 14336
    buffer_store_dwordx4 v[8:11], v12, s[24:27], s66 offen sc1
    s_mov_b32 s66, 15360
    buffer_store_dwordx4 v[8:11], v12, s[24:27], s66 offen sc1
    s_mov_b32 s66, 16384
    buffer_store_dwordx4 v[8:11], v12, s[24:27], s66 offen sc1
    s_mov_b32 s66, 17408
    buffer_store_dwordx4 v[8:11], v12, s[24:27], s66 offen sc1
    s_mov_b32 s66, 18432
    buffer_store_dwordx4 v[8:11], v12, s[24:27], s66 offen sc1
    s_mov_b32 s66, 19456
    buffer_store_dwordx4 v[8:11], v12, s[24:27], s66 offen sc1
    s_mov_b32 s66, 20480
    buffer_store_dwordx4 v[8:11], v12, s[24:27], s66 offen sc1
    s_mov_b32 s66, 21504
    buffer_store_dwordx4 v[8:11], v12, s[24:27], s66 offen sc1
    s_mov_b32 s66, 22528
    buffer_store_dwordx4 v[8:11], v12, s[24:27], s66 offen sc1
    s_mov_b32 s66, 23552
    buffer_store_dwordx4 v[8:11], v12, s[24:27], s66 offen sc1
    s_mov_b32 s66, 77824
    s_waitcnt vmcnt(0)
    buffer_store_dwordx4 v[8:11], v12, s[24:27], s66 offen offset:0 sc1
    buffer_store_dwordx4 v[8:11], v12, s[24:27], s66 offen offset:1024 sc1
    buffer_store_dwordx4 v[8:11], v12, s[24:27], s66 offen offset:2048 sc1
    buffer_store_dwordx4 v[8:11], v12, s[24:27], s66 offen offset:3072 sc1
L_noinit:
    s_cmp_eq_u32 s3, 7
    s_cbranch_scc0 L_pf7
    s_lshl_b32 s66, s23, 6
    s_lshl_b32 s67, s60, 2
    s_add_u32 s66, s66, s67
    s_add_u32 s66, s66, s61
    v_lshlrev_b32 v5, 7, v1
    v_lshrrev_b32 v6, 3, v1
    v_mul_u32_u24 v6, 2688, v6
    v_and_b32 v7, 7, v1
    v_min_u32 v7, 6, v7
    v_lshl_add_u32 v6, v7, 7, v6
    s_mul_i32 s67, s66, 10752
    s_mov_b64 exec, 0xffffffff
    buffer_load_dword v255, v6, s[28:31], s67 offen
    s_mul_i32 s67, s66, 3200
    s_bfm_b64 exec, 25, 0
    buffer_load_dword v255, v5, s[44:47], s67 offen
    s_mov_b64 exec, -1
L_pf7:
    v_and_b32 v5, 15, v1
    s_lshl_b32 s66, s61, 4
    v_add_u32 v5, s66, v5
    v_cvt_f32_u32 v5, v5
    v_mul_f32 v5, 0x3c800000, v5
    v_bfe_u32 v6, v1, 4, 1
    v_cvt_f32_u32 v6, v6
    v_mul_f32 v6, 0x3e800000, v6
    v_mul_f32 v7, v5, v4
    v_fmamk_f32 v6, v7, 0x40800000, v6
    v_mul_f32 v232, 0x41000000, v5
    v_cos_f32 v232, v232
    v_fmamk_f32 v236, v5, 0x00000000, v6
    v_fmamk_f32 v237, v5, 0x3f800000, v6
    v_fmamk_f32 v238, v5, 0x40000000, v6
    v_fmamk_f32 v239, v5, 0x40400000, v6
    v_fmamk_f32 v240, v5, 0x41000000, v6
    v_fmamk_f32 v241, v5, 0x41100000, v6
    v_fmamk_f32 v242, v5, 0x41200000, v6
    v_fmamk_f32 v243, v5, 0x41300000, v6
    v_add_f32 v232, v232, v232
    v_cos_f32 v216, v236
    v_sin_f32 v217, v236
    v_cos_f32 v218, v237
    v_sin_f32 v219, v237
    v_cos_f32 v220, v238
    v_sin_f32 v221, v238
    v_cos_f32 v222, v239
    v_sin_f32 v223, v239
    v_cos_f32 v224, v240
    v_sin_f32 v225, v240
    v_cos_f32 v226, v241
    v_sin_f32 v227, v241
    v_cos_f32 v228, v242
    v_sin_f32 v229, v242
    v_cos_f32 v230, v243
    v_sin_f32 v231, v243
    v_mov_b32 v233, v232
    v_cvt_pk_bf16_f32 v16, v216, v217
    v_cvt_pk_bf16_f32 v17, v218, v219
    v_cvt_pk_bf16_f32 v18, v220, v221
    v_cvt_pk_bf16_f32 v19, v222, v223
    v_cvt_pk_bf16_f32 v20, v224, v225
    v_cvt_pk_bf16_f32 v21, v226, v227
    v_cvt_pk_bf16_f32 v22, v228, v229
    v_cvt_pk_bf16_f32 v23, v230, v231
    v_fma_f32 v216, v232, v224, -v216
    v_fma_f32 v217, v233, v225, -v217
    v_fma_f32 v218, v232, v226, -v218
    v_fma_f32 v219, v233, v227, -v219
    v_fma_f32 v220, v232, v228, -v220
    v_fma_f32 v221, v233, v229, -v221
    v_fma_f32 v222, v232, v230, -v222
    v_fma_f32 v223, v233, v231, -v223
    v_cvt_pk_bf16_f32 v24, v216, v217
    v_cvt_pk_bf16_f32 v25, v218, v219
    v_cvt_pk_bf16_f32 v26, v220, v221
    v_cvt_pk_bf16_f32 v27, v222, v223
    v_fma_f32 v224, v232, v216, -v224
    v_fma_f32 v225, v233, v217, -v225
    v_fma_f32 v226, v232, v218, -v226
    v_fma_f32 v227, v233, v219, -v227
    v_fma_f32 v228, v232, v220, -v228
    v_fma_f32 v229, v233, v221, -v229
    v_fma_f32 v230, v232, v222, -v230
    v_fma_f32 v231, v233, v223, -v231
    v_cvt_pk_bf16_f32 v28, v224, v225
    v_cvt_pk_bf16_f32 v29, v226, v227
    v_cvt_pk_bf16_f32 v30, v228, v229
    v_cvt_pk_bf16_f32 v31, v230, v231
    v_fma_f32 v216, v232, v224, -v216
    v_fma_f32 v217, v233, v225, -v217
    v_fma_f32 v218, v232, v226, -v218
    v_fma_f32 v219, v233, v227, -v219
    v_fma_f32 v220, v232, v228, -v220
    v_fma_f32 v221, v233, v229, -v221
    v_fma_f32 v222, v232, v230, -v222
    v_fma_f32 v223, v233, v231, -v223
    v_cvt_pk_bf16_f32 v32, v216, v217
    v_cvt_pk_bf16_f32 v33, v218, v219
    v_cvt_pk_bf16_f32 v34, v220, v221
    v_cvt_pk_bf16_f32 v35, v222, v223
    v_fma_f32 v224, v232, v216, -v224
    v_fma_f32 v225, v233, v217, -v225
    v_fma_f32 v226, v232, v218, -v226
    v_fma_f32 v227, v233, v219, -v227
    v_fma_f32 v228, v232, v220, -v228
    v_fma_f32 v229, v233, v221, -v229
    v_fma_f32 v230, v232, v222, -v230
    v_fma_f32 v231, v233, v223, -v231
    v_cvt_pk_bf16_f32 v36, v224, v225
    v_cvt_pk_bf16_f32 v37, v226, v227
    v_cvt_pk_bf16_f32 v38, v228, v229
    v_cvt_pk_bf16_f32 v39, v230, v231
    v_fma_f32 v216, v232, v224, -v216
    v_fma_f32 v217, v233, v225, -v217
    v_fma_f32 v218, v232, v226, -v218
    v_fma_f32 v219, v233, v227, -v219
    v_fma_f32 v220, v232, v228, -v220
    v_fma_f32 v221, v233, v229, -v221
    v_fma_f32 v222, v232, v230, -v222
    v_fma_f32 v223, v233, v231, -v223
    v_cvt_pk_bf16_f32 v40, v216, v217
    v_cvt_pk_bf16_f32 v41, v218, v219
    v_cvt_pk_bf16_f32 v42, v220, v221
    v_cvt_pk_bf16_f32 v43, v222, v223
    v_fma_f32 v224, v232, v216, -v224
    v_fma_f32 v225, v233, v217, -v225
    v_fma_f32 v226, v232, v218, -v226
    v_fma_f32 v227, v233, v219, -v227
    v_fma_f32 v228, v232, v220, -v228
    v_fma_f32 v229, v233, v221, -v229
    v_fma_f32 v230, v232, v222, -v230
    v_fma_f32 v231, v233, v223, -v231
    v_cvt_pk_bf16_f32 v44, v224, v225
    v_cvt_pk_bf16_f32 v45, v226, v227
    v_cvt_pk_bf16_f32 v46, v228, v229
    v_cvt_pk_bf16_f32 v47, v230, v231
    v_cvt_f32_u32 v5, v2
    s_and_b32 s66, s61, 1
    s_lshl_b32 s66, s66, 10
    s_add_u32 s66, s66, s78
    v_lshl_add_u32 v6, v3, 8, s66
    v_cvt_f32_u32 v6, v6
    v_mul_f32 v6, v6, v5
    s_cmp_ge_u32 s61, 2
    s_cselect_b32 s66, 0x3e800000, 0
    v_mov_b32 v7, s66
    v_fmamk_f32 v6, v6, 0x3a000000, v7
    v_mul_f32 v5, 0x3d000000, v5
    v_fmamk_f32 v216, v5, 0x00000000, v6
    v_fmamk_f32 v217, v5, 0x3f800000, v6
    v_fmamk_f32 v218, v5, 0x40000000, v6
    v_fmamk_f32 v219, v5, 0x40400000, v6
    v_fmamk_f32 v220, v5, 0x41000000, v6
    v_fmamk_f32 v221, v5, 0x41100000, v6
    v_fmamk_f32 v222, v5, 0x41200000, v6
    v_fmamk_f32 v223, v5, 0x41300000, v6
    v_cos_f32 v216, v216
    v_cos_f32 v217, v217
    v_cos_f32 v218, v218
    v_cos_f32 v219, v219
    v_cos_f32 v220, v220
    v_cos_f32 v221, v221
    v_cos_f32 v222, v222
    v_cos_f32 v223, v223
    v_cvt_pk_bf16_f32 v208, v216, v217
    v_cvt_pk_bf16_f32 v209, v218, v219
    v_cvt_pk_bf16_f32 v210, v220, v221
    v_cvt_pk_bf16_f32 v211, v222, v223
    v_lshlrev_b32 v5, 6, v2
    v_add_u32 v5, s78, v5
    v_cvt_f32_u32 v5, v5
    v_mul_f32 v5, 0x3a000000, v5
    s_lshl_b32 s66, s61, 3
    v_lshl_add_u32 v6, v3, 2, s66
    v_cvt_f32_u32 v6, v6
    v_mul_f32 v6, v5, v6
    v_fmamk_f32 v224, v5, 0x00000000, v6
    v_fmamk_f32 v225, v5, 0x3f800000, v6
    v_fmamk_f32 v226, v5, 0x40000000, v6
    v_fmamk_f32 v227, v5, 0x40400000, v6
    v_cos_f32 v216, v224
    v_sin_f32 v217, v224
    v_cos_f32 v218, v225
    v_sin_f32 v219, v225
    v_cos_f32 v220, v226
    v_sin_f32 v221, v226
    v_cos_f32 v222, v227
    v_sin_f32 v223, v227
    v_mov_b32 v6, 0x36124925
    v_mov_b32 v7, v6
    v_mul_f32 v216, v216, v6
    v_mul_f32 v217, v217, v7
    v_mul_f32 v218, v218, v6
    v_mul_f32 v219, v219, v7
    v_mul_f32 v220, v220, v6
    v_mul_f32 v221, v221, v7
    v_mul_f32 v222, v222, v6
    v_mul_f32 v223, v223, v7
    v_cvt_pk_bf16_f32 v48, v216, v217
    v_cvt_pk_bf16_f32 v52, v217, -v216
    v_cvt_pk_bf16_f32 v49, v218, v219
    v_cvt_pk_bf16_f32 v53, v219, -v218
    v_cvt_pk_bf16_f32 v50, v220, v221
    v_cvt_pk_bf16_f32 v54, v221, -v220
    v_cvt_pk_bf16_f32 v51, v222, v223
    v_cvt_pk_bf16_f32 v55, v223, -v222
    v_mov_b32 v234, 0
    v_lshlrev_b32 v7, 4, v1
    v_and_b32 v6, 3, v1
    v_lshrrev_b32 v5, 2, v1
    v_lshlrev_b32 v5, 16, v5
    v_lshl_add_u32 v235, v6, 4, v5
    s_lshl_b32 s67, s61, 11
    s_add_u32 s66, s67, 90112
    v_add_u32 v242, s66, v7
    v_lshlrev_b32 v5, 6, v2
    v_lshl_add_u32 v5, v3, 4, v5
    v_add_u32 v241, s66, v5
    s_lshl_b32 s83, s57, 5
    s_add_u32 s83, s83, s58
    s_lshr_b32 s66, s83, 3
    s_lshl_b32 s68, s61, 9
    s_add_u32 s66, s66, s68
    s_mul_i32 s66, s66, 225
    s_lshl_b32 s68, s52, 5
    s_add_u32 s66, s66, s68
    v_mul_u32_u24 v5, 28800, v3
    v_add3_u32 v5, v5, v2, s66
    v_lshlrev_b32 v236, 1, v5
    v_bfe_u32 v12, v1, 4, 1
    v_lshlrev_b32 v5, 2, v2
    v_lshl_add_u32 v238, v3, 9, v5
    s_cmp_eq_u32 s52, 7
    s_cselect_b32 s68, 0x200, -1
    v_and_b32 v237, s68, v238
    v_lshl_add_u32 v243, v3, 17, v5
    v_lshl_add_u32 v244, v3, 18, v5
    v_add_u32 v240, 57344, v7
    v_add_u32 v239, s67, v240
    s_add_u32 s73, s61, 3
    s_cmp_eq_u32 s61, 0
    s_cselect_b32 s73, 7, s73
    s_lshl_b32 s66, s61, 12
    v_add_u32 v248, s66, v240
    s_lshl_b32 s66, s73, 12
    v_add_u32 v249, s66, v240
    v_bfe_u32 v13, v1, 2, 2
    v_lshrrev_b32 v5, 4, v1
    v_xor_b32 v245, v13, v5
    s_sub_u32 s66, s80, 1
    v_min_u32 v245, s66, v245
    v_add_u32 v245, s81, v245
    v_lshlrev_b32 v245, 6, v245
    v_mul_u32_u24 v5, 896, v5
    v_add_u32 v5, v5, v245
    v_lshl_add_u32 v5, v6, 4, v5
    s_mul_i32 s66, s61, 3584
    v_add_u32 v245, s66, v5
    v_xor_b32 v5, s61, v13
    v_lshlrev_b32 v5, 6, v5
    v_lshl_add_u32 v5, v13, 8, v5
    v_and_b32 v6, 1, v1
    v_lshl_add_u32 v5, v6, 5, v5
    v_lshl_add_u32 v5, v12, 4, v5
    v_bfe_u32 v6, v1, 1, 1
    v_lshl_add_u32 v5, v6, 3, v5
    v_add_u32 v247, 86016, v5
    v_lshl_add_u32 v246, v3, 10, v247
    s_mov_b32 s24, s20
    s_mov_b32 s25, s21
    s_mov_b32 s26, 16777216
    s_mov_b32 s27, 0x20000
    s_mov_b32 s48, s16
    s_mov_b32 s49, s17
    s_mov_b32 s50, 3670016
    s_mov_b32 s51, 0x20000
    v_lshrrev_b32 v6, 3, v1
    v_and_b32 v5, 7, v1
    v_lshrrev_b32 v8, 4, v1
    v_xor_b32 v5, v5, v8
    s_and_b32 s66, s61, 1
    s_lshl_b32 s66, s66, 2
    v_xor_b32 v5, s66, v5
    v_mul_u32_u24 v6, 57344, v6
    s_mul_i32 s67, s61, 458752
    s_mul_i32 s68, s78, 896
    s_add_u32 s67, s67, s68
    v_add_u32 v6, s67, v6
    v_lshl_add_u32 v70, v5, 4, v6
    s_lshl_b32 s66, s61, 10
    s_add_u32 s70, s66, 86016
    s_mov_b32 s68, 86016
    v_and_b32 v216, 31, v1
    v_lshrrev_b32 v217, 5, v1
    v_bfe_u32 v218, v1, 1, 3
    v_xor_b32 v217, v217, v218
    v_lshlrev_b32 v216, 7, v216
    v_add_u32 v216, s68, v216
    v_xor_b32 v218, 0, v217
    v_lshl_add_u32 v8, v218, 4, v216
    v_xor_b32 v218, 2, v217
    v_lshl_add_u32 v9, v218, 4, v216
    v_xor_b32 v218, 4, v217
    v_lshl_add_u32 v10, v218, 4, v216
    v_xor_b32 v218, 6, v217
    v_lshl_add_u32 v11, v218, 4, v216
    v_mov_b32 v14, 159872
    v_mov_b32 v15, 1
    v_mov_b32 v251, 159744
    s_lshl_b32 s67, s79, 1
    s_mov_b32 s64, 1048576
L_lw_28:
    ds_read_b32 v254, v251 offset:0
    s_waitcnt lgkmcnt(0)
    v_readfirstlane_b32 s66, v254
    s_cmp_ge_u32 s66, 4
    s_cbranch_scc1 L_lwd_29
    s_sleep 1
    s_sub_u32 s64, s64, 1
    s_cbranch_scc0 L_lw_28
    s_mov_b32 s64, 34
    s_branch L_fail
L_lwd_29:
    ds_read_b64 v[232:233], v251 offset:64
    v_lshlrev_b32 v250, 7, v1
    s_add_u32 s74, s20, 4096
    s_addc_u32 s75, s21, 0
    s_waitcnt lgkmcnt(0)
    v_readfirstlane_b32 s62, v232
    v_readfirstlane_b32 s63, v233
    s_nop 0
    s_mov_b32 s64, 1048576
L_lw_30:
    ds_read_b32 v254, v251 offset:8
    s_waitcnt lgkmcnt(0)
    v_readfirstlane_b32 s66, v254
    s_cmp_ge_u32 s66, 4
    s_cbranch_scc1 L_lwd_31
    s_sleep 1
    s_sub_u32 s64, s64, 1
    s_cbranch_scc0 L_lw_30
    s_mov_b32 s64, 20
    s_branch L_fail
L_lwd_31:
    s_mov_b32 s64, 1048576
L_lw_32:
    ds_read_b32 v254, v251 offset:16
    s_waitcnt lgkmcnt(0)
    v_readfirstlane_b32 s66, v254
    s_cmp_ge_u32 s66, 4
    s_cbranch_scc1 L_lwd_33
    s_sleep 1
    s_sub_u32 s64, s64, 1
    s_cbranch_scc0 L_lw_32
    s_mov_b32 s64, 38
    s_branch L_fail
L_lwd_33:
    s_add_u32 s68, s67, 1
    s_lshr_b32 s69, s68, 1
    s_lshl_b32 s69, s69, 14
    s_and_b32 s22, s67, 1
    s_lshl_b32 s22, s22, 12
    s_sub_u32 s69, s69, s22
    s_add_u32 m0, s70, s69
    s_lshl_b32 s22, s67, 7
    buffer_load_dwordx4 v70, s[32:35], s22 offen nt lds
    s_cmp_eq_u32 s68, 7
    s_cselect_b32 s67, 0, s68
    s_add_u32 s68, s67, 1
    s_lshr_b32 s69, s68, 1
    s_lshl_b32 s69, s69, 14
    s_and_b32 s22, s67, 1
    s_lshl_b32 s22, s22, 12
    s_sub_u32 s69, s69, s22
    s_add_u32 m0, s70, s69
    s_lshl_b32 s22, s67, 7
    buffer_load_dwordx4 v70, s[32:35], s22 offen nt lds
    s_cmp_eq_u32 s68, 7
    s_cselect_b32 s67, 0, s68
    s_add_u32 s68, s67, 1
    s_lshr_b32 s69, s68, 1
    s_lshl_b32 s69, s69, 14
    s_and_b32 s22, s67, 1
    s_lshl_b32 s22, s22, 12
    s_sub_u32 s69, s69, s22
    s_add_u32 m0, s70, s69
    s_lshl_b32 s22, s67, 7
    buffer_load_dwordx4 v70, s[32:35], s22 offen nt lds
    s_cmp_eq_u32 s68, 7
    s_cselect_b32 s67, 0, s68
    s_add_u32 s68, s67, 1
    s_lshr_b32 s69, s68, 1
    s_lshl_b32 s69, s69, 14
    s_and_b32 s22, s67, 1
    s_lshl_b32 s22, s22, 12
    s_sub_u32 s69, s69, s22
    s_add_u32 m0, s70, s69
    s_lshl_b32 s22, s67, 7
    buffer_load_dwordx4 v70, s[32:35], s22 offen nt lds
    s_cmp_eq_u32 s68, 7
    s_cselect_b32 s67, 0, s68
    s_add_u32 s68, s67, 1
    s_lshr_b32 s69, s68, 1
    s_lshl_b32 s69, s69, 14
    s_and_b32 s22, s67, 1
    s_lshl_b32 s22, s22, 12
    s_sub_u32 s69, s69, s22
    s_add_u32 m0, s70, s69
    s_lshl_b32 s22, s67, 7
    buffer_load_dwordx4 v70, s[32:35], s22 offen nt lds
    s_cmp_eq_u32 s68, 7
    s_cselect_b32 s67, 0, s68
    s_add_u32 s68, s67, 1
    s_lshr_b32 s69, s68, 1
    s_lshl_b32 s69, s69, 14
    s_and_b32 s22, s67, 1
    s_lshl_b32 s22, s22, 12
    s_sub_u32 s69, s69, s22
    s_add_u32 m0, s70, s69
    s_lshl_b32 s22, s67, 7
    buffer_load_dwordx4 v70, s[32:35], s22 offen nt lds
    s_cmp_eq_u32 s68, 7
    s_cselect_b32 s67, 0, s68
    s_add_u32 s68, s67, 1
    s_lshr_b32 s69, s68, 1
    s_lshl_b32 s69, s69, 14
    s_and_b32 s22, s67, 1
    s_lshl_b32 s22, s22, 12
    s_sub_u32 s69, s69, s22
    s_add_u32 m0, s70, s69
    s_lshl_b32 s22, s67, 7
    buffer_load_dwordx4 v70, s[32:35], s22 offen nt lds
    s_cmp_eq_u32 s68, 7
    s_cselect_b32 s67, 0, s68
    v_add_u32 v13, 147456, v7
    s_lshl_b32 s66, s61, 10
    v_add_u32 v5, s66, v13
    ds_write_b128 v5, v[208:211]
    s_cmp_eq_u32 s61, 0
    s_cbranch_scc0 L_chkd
    s_and_b32 s67, s2, 31
    s_lshl_b32 s67, s67, 7
    s_add_u32 s67, s67, 73728
    s_mov_b32 s64, 131072
L_chk:
    s_load_dwordx2 s[76:77], s[74:75], s67 glc
    s_waitcnt lgkmcnt(0)
    s_cmp_eq_u64 s[76:77], s[62:63]
    s_cbranch_scc1 L_chkd
    s_sleep 4
    s_sub_u32 s64, s64, 1
    s_cbranch_scc0 L_chk
    s_mov_b32 s64, 35
    s_branch L_fail
L_chkd:
    s_waitcnt vmcnt(0)
    s_add_u32 s65, s65, 4
    s_mov_b64 exec, 1
    ds_add_u32 v14, v15
    s_mov_b64 exec, -1
    s_mov_b32 s64, 1048576
L_lb_34:
    ds_read_b32 v254, v14
    s_waitcnt lgkmcnt(0)
    v_readfirstlane_b32 s66, v254
    s_cmp_ge_u32 s66, s65
    s_cbranch_scc1 L_lbd_35
    s_sleep 1
    s_sub_u32 s64, s64, 1
    s_cbranch_scc0 L_lb_34
    s_mov_b32 s64, 16
    s_branch L_fail
L_lbd_35:
    ds_read_b128 v[216:219], v8 offset:0
    ds_read_b128 v[220:223], v9 offset:0
    ds_read_b128 v[224:227], v10 offset:0
    ds_read_b128 v[228:231], v11 offset:0
    ds_read_b128 v[72:75], v8 offset:12288
    ds_read_b128 v[76:79], v9 offset:12288
    ds_read_b128 v[80:83], v10 offset:12288
    ds_read_b128 v[84:87], v11 offset:12288
    s_setprio 0
    s_waitcnt lgkmcnt(7)
    v_mfma_f32_32x32x16_bf16 v[200:215], v[216:219], v[88:91], 0
    ds_read_b128 v[88:91], v8 offset:16384
    s_waitcnt lgkmcnt(7)
    v_mfma_f32_32x32x16_bf16 v[200:215], v[220:223], v[92:95], v[200:215]
    ds_read_b128 v[92:95], v9 offset:16384
    s_waitcnt lgkmcnt(7)
    v_mfma_f32_32x32x16_bf16 v[200:215], v[224:227], v[96:99], v[200:215]
    ds_read_b128 v[96:99], v10 offset:16384
    s_waitcnt lgkmcnt(7)
    v_mfma_f32_32x32x16_bf16 v[200:215], v[228:231], v[100:103], v[200:215]
    ds_read_b128 v[100:103], v11 offset:16384
    s_waitcnt lgkmcnt(7)
    v_mfma_f32_32x32x16_bf16 v[200:215], v[72:75], v[104:107], v[200:215]
    ds_read_b128 v[104:107], v8 offset:28672
    s_waitcnt lgkmcnt(7)
    v_mfma_f32_32x32x16_bf16 v[200:215], v[76:79], v[108:111], v[200:215]
    ds_read_b128 v[108:111], v9 offset:28672
    s_waitcnt lgkmcnt(7)
    v_mfma_f32_32x32x16_bf16 v[200:215], v[80:83], v[112:115], v[200:215]
    ds_read_b128 v[112:115], v10 offset:28672
    s_waitcnt lgkmcnt(7)
    v_mfma_f32_32x32x16_bf16 v[200:215], v[84:87], v[116:119], v[200:215]
    ds_read_b128 v[116:119], v11 offset:28672
    s_waitcnt lgkmcnt(7)
    v_mfma_f32_32x32x16_bf16 v[200:215], v[88:91], v[120:123], v[200:215]
    ds_read_b128 v[120:123], v8 offset:32768
    s_waitcnt lgkmcnt(7)
    v_mfma_f32_32x32x16_bf16 v[200:215], v[92:95], v[124:127], v[200:215]
    ds_read_b128 v[124:127], v9 offset:32768
    s_waitcnt lgkmcnt(7)
    v_mfma_f32_32x32x16_bf16 v[200:215], v[96:99], v[128:131], v[200:215]
    ds_read_b128 v[128:131], v10 offset:32768
    s_waitcnt lgkmcnt(7)
    v_mfma_f32_32x32x16_bf16 v[200:215], v[100:103], v[132:135], v[200:215]
    ds_read_b128 v[132:135], v11 offset:32768
    s_waitcnt lgkmcnt(7)
    v_mfma_f32_32x32x16_bf16 v[200:215], v[104:107], v[136:139], v[200:215]
    ds_read_b128 v[136:139], v8 offset:45056
    s_waitcnt lgkmcnt(7)
    v_mfma_f32_32x32x16_bf16 v[200:215], v[108:111], v[140:143], v[200:215]
    ds_read_b128 v[140:143], v9 offset:45056
    s_waitcnt lgkmcnt(7)
    v_mfma_f32_32x32x16_bf16 v[200:215], v[112:115], v[144:147], v[200:215]
    ds_read_b128 v[144:147], v10 offset:45056
    s_waitcnt lgkmcnt(7)
    v_mfma_f32_32x32x16_bf16 v[200:215], v[116:119], v[148:151], v[200:215]
    ds_read_b128 v[148:151], v11 offset:45056
    s_waitcnt lgkmcnt(7)
    v_mfma_f32_32x32x16_bf16 v[200:215], v[120:123], v[152:155], v[200:215]
    ds_read_b128 v[152:155], v8 offset:49152
    s_waitcnt lgkmcnt(7)
    v_mfma_f32_32x32x16_bf16 v[200:215], v[124:127], v[156:159], v[200:215]
    ds_read_b128 v[156:159], v9 offset:49152
    s_waitcnt lgkmcnt(7)
    v_mfma_f32_32x32x16_bf16 v[200:215], v[128:131], v[160:163], v[200:215]
    ds_read_b128 v[160:163], v10 offset:49152
    s_waitcnt lgkmcnt(7)
    v_mfma_f32_32x32x16_bf16 v[200:215], v[132:135], v[164:167], v[200:215]
    ds_read_b128 v[164:167], v11 offset:49152
    s_waitcnt lgkmcnt(7)
    v_mfma_f32_32x32x16_bf16 v[200:215], v[136:139], v[168:171], v[200:215]
    s_waitcnt lgkmcnt(6)
    v_mfma_f32_32x32x16_bf16 v[200:215], v[140:143], v[172:175], v[200:215]
    s_waitcnt lgkmcnt(5)
    v_mfma_f32_32x32x16_bf16 v[200:215], v[144:147], v[176:179], v[200:215]
    s_waitcnt lgkmcnt(4)
    v_mfma_f32_32x32x16_bf16 v[200:215], v[148:151], v[180:183], v[200:215]
    s_waitcnt lgkmcnt(3)
    v_mfma_f32_32x32x16_bf16 v[200:215], v[152:155], v[184:187], v[200:215]
    ds_read_b128 v[120:123], v13 offset:0
    s_waitcnt lgkmcnt(3)
    v_mfma_f32_32x32x16_bf16 v[200:215], v[156:159], v[188:191], v[200:215]
    ds_read_b128 v[124:127], v13 offset:1024
    s_waitcnt lgkmcnt(3)
    v_mfma_f32_32x32x16_bf16 v[200:215], v[160:163], v[192:195], v[200:215]
    ds_read_b128 v[128:131], v13 offset:2048
    s_waitcnt lgkmcnt(3)
    v_mfma_f32_32x32x16_bf16 v[200:215], v[164:167], v[196:199], v[200:215]
    ds_read_b128 v[132:135], v13 offset:3072
    s_setprio 2
    s_mov_b32 s64, 1048576
L_lw_36:
    ds_read_b32 v254, v251 offset:0
    s_waitcnt lgkmcnt(0)
    v_readfirstlane_b32 s66, v254
    s_cmp_ge_u32 s66, 8
    s_cbranch_scc1 L_lwd_37
    s_sleep 1
    s_sub_u32 s64, s64, 1
    s_cbranch_scc0 L_lw_36
    s_mov_b32 s64, 27
    s_branch L_fail
L_lwd_37:
    s_lshl_b32 s66, s61, 11
    s_add_u32 s66, s66, 49152
    v_add_u32 v5, s66, v7
    ds_write_b128 v5, v[48:51]
    ds_write_b128 v5, v[52:55] offset:1024
    s_lshr_b32 s66, s82, 1
    s_lshl_b32 s66, s66, 13
    s_lshl_b32 s67, s78, 7
    s_add_u32 s67, s67, 6815744
    s_add_u32 s66, s66, s67
    s_and_b32 s68, s82, 1
    s_lshl_b32 s68, s68, 6
    s_add_u32 s66, s66, s68
    s_add_u32 s68, s66, 1048576
    s_cmp_ge_u32 s61, s80
    s_cbranch_scc1 L_a1done
    s_waitcnt lgkmcnt(0)
    v_cvt_pk_bf16_f32 v216, v200, v201
    v_cvt_pk_bf16_f32 v217, v202, v203
    v_cvt_pk_bf16_f32 v218, v204, v205
    v_cvt_pk_bf16_f32 v219, v206, v207
    v_cvt_pk_bf16_f32 v220, v208, v209
    v_cvt_pk_bf16_f32 v221, v210, v211
    v_cvt_pk_bf16_f32 v222, v212, v213
    v_cvt_pk_bf16_f32 v223, v214, v215
    v_mfma_f32_32x32x16_bf16 v[88:103], v[216:219], v[120:123], 0
    v_mfma_f32_32x32x16_bf16 v[104:119], v[216:219], v[128:131], 0
    v_mfma_f32_32x32x16_bf16 v[88:103], v[220:223], v[124:127], v[88:103]
    v_mfma_f32_32x32x16_bf16 v[104:119], v[220:223], v[132:135], v[104:119]
    s_nop 11
    v_sub_f32 v200, v88, v112
    v_sub_f32 v201, v89, v113
    v_add_f32 v208, v96, v104
    v_add_f32 v209, v97, v105
    v_sub_f32 v202, v90, v114
    v_sub_f32 v203, v91, v115
    v_add_f32 v210, v98, v106
    v_add_f32 v211, v99, v107
    v_sub_f32 v204, v92, v116
    v_sub_f32 v205, v93, v117
    v_add_f32 v212, v100, v108
    v_add_f32 v213, v101, v109
    v_sub_f32 v206, v94, v118
    v_sub_f32 v207, v95, v119
    v_add_f32 v214, v102, v110
    v_add_f32 v215, v103, v111
    v_cvt_pk_bf16_f32 v224, v200, v208
    v_cvt_pk_bf16_f32 v225, v201, v209
    v_cvt_pk_bf16_f32 v226, v202, v210
    v_cvt_pk_bf16_f32 v227, v203, v211
    v_cvt_pk_bf16_f32 v228, v204, v212
    v_cvt_pk_bf16_f32 v229, v205, v213
    v_cvt_pk_bf16_f32 v230, v206, v214
    v_cvt_pk_bf16_f32 v231, v207, v215
    s_cmp_lg_u32 s82, 0
    s_cbranch_scc1 L_a1st
    s_mov_b32 exec_hi, 0
    v_cvt_pk_bf16_f32 v224, v88, v104
    v_cvt_pk_bf16_f32 v6, v96, v112
    v_lshlrev_b32 v5, 2, v2
    s_mov_b32 exec_hi, -1
L_a1st:
    ds_write_b128 v241, v[224:227]
    ds_write_b128 v241, v[228:231] offset:32
    ds_read_b128 v[216:219], v242
    ds_read_b128 v[220:223], v242 offset:1024
    s_mov_b32 s22, s66
    s_waitcnt lgkmcnt(0)
    s_mov_b32 s64, 1048576
L_lw_38:
    ds_read_b32 v254, v251 offset:12
    s_waitcnt lgkmcnt(0)
    v_readfirstlane_b32 s66, v254
    s_cmp_ge_u32 s66, 4
    s_cbranch_scc1 L_lwd_39
    s_sleep 1
    s_sub_u32 s64, s64, 1
    s_cbranch_scc0 L_lw_38
    s_mov_b32 s64, 28
    s_branch L_fail
L_lwd_39:
    s_cmp_lg_u32 s82, 0
    s_cbranch_scc1 L_a1st2
    s_mov_b32 exec_hi, 0
    s_add_u32 s67, s67, 4288249856
    buffer_store_dword v6, v5, s[24:27], s67 offen sc1
    s_mov_b32 exec_hi, -1
L_a1st2:
    buffer_store_dwordx4 v[216:219], v235, s[24:27], s22 offen sc1
    buffer_store_dwordx4 v[220:223], v235, s[24:27], s68 offen sc1
L_a1done:
    s_waitcnt vmcnt(0)
    s_mov_b64 exec, 1
    ds_add_rtn_u32 v254, v14, v15 offset:8
    s_mov_b64 exec, -1
    s_waitcnt lgkmcnt(0)
    v_readfirstlane_b32 s66, v254
    s_cmp_eq_u32 s66, 3
    s_cbranch_scc0 L_arr_40
    s_mov_b32 s66, 1
    s_and_b32 s67, s2, 7
    s_lshl_b32 s67, s67, 7
    s_add_u32 s67, s67, 0
    s_atomic_add s66, s[74:75], s67 glc
    s_waitcnt lgkmcnt(0)
    s_sub_u32 s66, s66, s62
    s_cmp_eq_u32 s66, 31
    s_cbranch_scc0 L_arr_40
    s_mov_b32 s67, 8192
    buffer_atomic_add v15, v250, s[24:27], s67 offen sc1
    s_add_u32 s67, s67, 8192
    buffer_atomic_add v15, v250, s[24:27], s67 offen sc1
    s_add_u32 s67, s67, 8192
    s_mov_b64 exec, -1
L_arr_40:
    s_mov_b32 s64, 1048576
L_lw_41:
    ds_read_b32 v254, v251 offset:12
    s_waitcnt lgkmcnt(0)
    v_readfirstlane_b32 s66, v254
    s_cmp_ge_u32 s66, 4
    s_cbranch_scc1 L_lwd_42
    s_sleep 1
    s_sub_u32 s64, s64, 1
    s_cbranch_scc0 L_lw_41
    s_mov_b32 s64, 29
    s_branch L_fail
L_lwd_42:
    v_mov_b32 v208, -1
    v_mov_b32 v209, -1
    v_mov_b32 v210, -1
    v_mov_b32 v211, -1
    s_lshl_b32 s66, s60, 2
    s_add_u32 s66, s66, s61
    s_lshl_b32 s66, s66, 4
    s_add_u32 s66, s66, s59
    s_lshl_b32 s66, s66, 11
    s_add_u32 s66, s66, 4718592
    s_mov_b32 s72, s66
    s_lshl_b32 s70, s61, 10
    s_add_u32 s70, s70, 86016
    s_and_b32 s67, s2, 31
    s_mul_i32 s68, s61, 32
    s_add_u32 s67, s67, s68
    s_lshl_b32 s67, s67, 7
    s_add_u32 s67, s67, 4096
    s_mov_b32 s64, 131072
    s_add_u32 s68, s62, 8
    s_waitcnt lgkmcnt(0)
    s_mov_b32 s66, 0
    s_atomic_or s66, s[74:75], s67 glc
    s_waitcnt lgkmcnt(0)
    s_setprio 0
    buffer_store_dwordx4 v[208:211], v7, s[24:27], s72 offen offset:0 sc1
    buffer_store_dwordx4 v[208:211], v7, s[24:27], s72 offen offset:1024 sc1
    s_setprio 2
    s_cmp_eq_u32 s66, s68
    s_cbranch_scc1 L_sw_43d
L_sw_43:
    s_mov_b32 s66, 0
    s_atomic_or s66, s[74:75], s67 glc
    s_waitcnt lgkmcnt(0)
    s_cmp_eq_u32 s66, s68
    s_cbranch_scc1 L_sw_43d
    s_sleep 2
    s_sub_u32 s64, s64, 1
    s_cbranch_scc0 L_sw_43
    s_mov_b32 s64, 32
    s_branch L_fail
L_sw_43d:
    s_lshl_b32 s67, s61, 11
    s_lshl_b32 s66, s83, 13
    s_add_u32 s66, s66, s67
    s_add_u32 s66, s66, 6815744
    s_lshr_b32 s68, s83, 3
    s_lshl_b32 s68, s68, 2
    s_add_u32 s68, s68, s67
    s_add_u32 s68, s68, 98304
    s_cmp_eq_u32 s52, 7
    s_cselect_b32 s66, s68, s66
    s_setprio 0
    buffer_load_dword v168, v237, s[24:27], s66 offen offset:0 sc1
    buffer_load_dword v169, v237, s[24:27], s66 offen offset:128 sc1
    buffer_load_dword v170, v237, s[24:27], s66 offen offset:256 sc1
    buffer_load_dword v171, v237, s[24:27], s66 offen offset:384 sc1
    buffer_load_dword v172, v237, s[24:27], s66 offen offset:1024 sc1
    buffer_load_dword v173, v237, s[24:27], s66 offen offset:1152 sc1
    buffer_load_dword v174, v237, s[24:27], s66 offen offset:1280 sc1
    buffer_load_dword v175, v237, s[24:27], s66 offen offset:1408 sc1
    s_setprio 2
    s_setprio 0
    s_mov_b32 s66, 0
    buffer_load_short_d16_hi v72, v236, s[36:39], s66 offen nt
    buffer_load_short_d16_hi v80, v236, s[40:43], s66 offen nt
    s_mov_b32 s66, 14400
    buffer_load_short_d16_hi v73, v236, s[36:39], s66 offen nt
    buffer_load_short_d16_hi v81, v236, s[40:43], s66 offen nt
    s_mov_b32 s66, 28800
    buffer_load_short_d16_hi v74, v236, s[36:39], s66 offen nt
    buffer_load_short_d16_hi v82, v236, s[40:43], s66 offen nt
    s_mov_b32 s66, 43200
    buffer_load_short_d16_hi v75, v236, s[36:39], s66 offen nt
    buffer_load_short_d16_hi v83, v236, s[40:43], s66 offen nt
    s_mov_b32 s66, 115200
    buffer_load_short_d16_hi v76, v236, s[36:39], s66 offen nt
    buffer_load_short_d16_hi v84, v236, s[40:43], s66 offen nt
    s_mov_b32 s66, 129600
    buffer_load_short_d16_hi v77, v236, s[36:39], s66 offen nt
    buffer_load_short_d16_hi v85, v236, s[40:43], s66 offen nt
    s_mov_b32 s66, 144000
    buffer_load_short_d16_hi v78, v236, s[36:39], s66 offen nt
    buffer_load_short_d16_hi v86, v236, s[40:43], s66 offen nt
    s_mov_b32 s66, 158400
    buffer_load_short_d16_hi v79, v236, s[36:39], s66 offen nt
    buffer_load_short_d16_hi v87, v236, s[40:43], s66 offen nt
    s_setprio 2
    s_waitcnt vmcnt(16)
    ds_write_b128 v239, v[168:171]
    ds_write_b128 v239, v[172:175] offset:1024
    s_add_u32 s65, s65, 4
    s_mov_b64 exec, 1
    ds_add_u32 v14, v15
    s_mov_b64 exec, -1
    s_mov_b32 s64, 1048576
L_lb_46:
    ds_read_b32 v254, v14
    s_waitcnt lgkmcnt(0)
    v_readfirstlane_b32 s66, v254
    s_cmp_ge_u32 s66, s65
    s_cbranch_scc1 L_lbd_47
    s_sleep 1
    s_sub_u32 s64, s64, 1
    s_cbranch_scc0 L_lb_46
    s_mov_b32 s64, 6
    s_branch L_fail
L_lbd_47:
    ds_read_b128 v[168:171], v240 offset:0
    ds_read_b128 v[172:175], v240 offset:1024
    ds_read_b128 v[176:179], v240 offset:2048
    ds_read_b128 v[180:183], v240 offset:3072
    ds_read_b128 v[184:187], v240 offset:4096
    ds_read_b128 v[188:191], v240 offset:5120
    ds_read_b128 v[192:195], v240 offset:6144
    ds_read_b128 v[196:199], v240 offset:7168
    s_setprio 0
    s_waitcnt lgkmcnt(7)
    v_mfma_f32_32x32x16_bf16 v[152:167], v[16:19], v[168:171], 0
    s_add_u32 m0, s70, 0
    s_mov_b32 s71, 0
    buffer_load_dwordx4 v245, s[44:47], s71 offen lds
    s_waitcnt lgkmcnt(6)
    v_mfma_f32_32x32x16_bf16 v[152:167], v[20:23], v[172:175], v[152:167]
    s_add_u32 m0, s70, 4096
    s_mov_b32 s71, 14336
    buffer_load_dwordx4 v245, s[44:47], s71 offen lds
    s_waitcnt lgkmcnt(5)
    v_mfma_f32_32x32x16_bf16 v[152:167], v[24:27], v[176:179], v[152:167]
    s_add_u32 m0, s70, 8192
    s_mov_b32 s71, 28672
    buffer_load_dwordx4 v245, s[44:47], s71 offen lds
    s_waitcnt lgkmcnt(4)
    v_mfma_f32_32x32x16_bf16 v[152:167], v[28:31], v[180:183], v[152:167]
    s_add_u32 m0, s70, 12288
    s_mov_b32 s71, 43008
    buffer_load_dwordx4 v245, s[44:47], s71 offen lds
    s_waitcnt lgkmcnt(3)
    v_mfma_f32_32x32x16_bf16 v[152:167], v[32:35], v[184:187], v[152:167]
    s_add_u32 m0, s70, 16384
    s_mov_b32 s71, 57344
    buffer_load_dwordx4 v245, s[44:47], s71 offen lds
    s_waitcnt lgkmcnt(2)
    v_mfma_f32_32x32x16_bf16 v[152:167], v[36:39], v[188:191], v[152:167]
    s_add_u32 m0, s70, 20480
    s_mov_b32 s71, 71680
    buffer_load_dwordx4 v245, s[44:47], s71 offen lds
    s_waitcnt lgkmcnt(1)
    v_mfma_f32_32x32x16_bf16 v[152:167], v[40:43], v[192:195], v[152:167]
    s_add_u32 m0, s70, 24576
    s_mov_b32 s71, 86016
    buffer_load_dwordx4 v245, s[44:47], s71 offen lds
    s_waitcnt lgkmcnt(0)
    v_mfma_f32_32x32x16_bf16 v[152:167], v[44:47], v[196:199], v[152:167]
    s_add_u32 m0, s70, 28672
    s_mov_b32 s71, 100352
    buffer_load_dwordx4 v245, s[44:47], s71 offen lds
    s_setprio 2
    s_waitcnt vmcnt(8)
    s_cmp_eq_u32 s52, 7
    s_cbranch_scc0 L_a2nx
    v_mov_b32 v200, v72
    v_xor_b32 v72, 0x80000000, v80
    v_mov_b32 v80, v200
    v_mov_b32 v200, v73
    v_xor_b32 v73, 0x80000000, v81
    v_mov_b32 v81, v200
    v_mov_b32 v200, v74
    v_xor_b32 v74, 0x80000000, v82
    v_mov_b32 v82, v200
    v_mov_b32 v200, v75
    v_xor_b32 v75, 0x80000000, v83
    v_mov_b32 v83, v200
    v_mov_b32 v200, v76
    v_xor_b32 v76, 0x80000000, v84
    v_mov_b32 v84, v200
    v_mov_b32 v200, v77
    v_xor_b32 v77, 0x80000000, v85
    v_mov_b32 v85, v200
    v_mov_b32 v200, v78
    v_xor_b32 v78, 0x80000000, v86
    v_mov_b32 v86, v200
    v_mov_b32 v200, v79
    v_xor_b32 v79, 0x80000000, v87
    v_mov_b32 v87, v200
L_a2nx:
    s_nop 4
    v_pk_mul_f32 v[168:169], v[152:153], v[72:73]
    v_pk_mul_f32 v[176:177], v[152:153], v[80:81]
    v_pk_fma_f32 v[168:169], v[160:161], v[80:81], v[168:169] neg_lo:[1,0,0] neg_hi:[1,0,0]
    v_pk_fma_f32 v[176:177], v[160:161], v[72:73], v[176:177] neg_lo:[1,0,1] neg_hi:[1,0,1]
    v_cvt_pk_bf16_f32 v200, v168, v176
    v_cvt_pk_bf16_f32 v201, v169, v177
    v_pk_mul_f32 v[170:171], v[154:155], v[74:75]
    v_pk_mul_f32 v[178:179], v[154:155], v[82:83]
    v_pk_fma_f32 v[170:171], v[162:163], v[82:83], v[170:171] neg_lo:[1,0,0] neg_hi:[1,0,0]
    v_pk_fma_f32 v[178:179], v[162:163], v[74:75], v[178:179] neg_lo:[1,0,1] neg_hi:[1,0,1]
    v_cvt_pk_bf16_f32 v202, v170, v178
    v_cvt_pk_bf16_f32 v203, v171, v179
    v_pk_mul_f32 v[172:173], v[156:157], v[76:77]
    v_pk_mul_f32 v[180:181], v[156:157], v[84:85]
    v_pk_fma_f32 v[172:173], v[164:165], v[84:85], v[172:173] neg_lo:[1,0,0] neg_hi:[1,0,0]
    v_pk_fma_f32 v[180:181], v[164:165], v[76:77], v[180:181] neg_lo:[1,0,1] neg_hi:[1,0,1]
    v_cvt_pk_bf16_f32 v204, v172, v180
    v_cvt_pk_bf16_f32 v205, v173, v181
    v_pk_mul_f32 v[174:175], v[158:159], v[78:79]
    v_pk_mul_f32 v[182:183], v[158:159], v[86:87]
    v_pk_fma_f32 v[174:175], v[166:167], v[86:87], v[174:175] neg_lo:[1,0,0] neg_hi:[1,0,0]
    v_pk_fma_f32 v[182:183], v[166:167], v[78:79], v[182:183] neg_lo:[1,0,1] neg_hi:[1,0,1]
    v_cvt_pk_bf16_f32 v206, v174, v182
    v_cvt_pk_bf16_f32 v207, v175, v183
    ds_write_b128 v239, v[200:203] offset:8192
    ds_write_b128 v239, v[204:207] offset:9216
    s_add_u32 s65, s65, 4
    s_mov_b64 exec, 1
    ds_add_u32 v14, v15
    s_mov_b64 exec, -1
    s_mov_b32 s64, 1048576
L_lb_48:
    ds_read_b32 v254, v14
    s_waitcnt lgkmcnt(0)
    v_readfirstlane_b32 s66, v254
    s_cmp_ge_u32 s66, s65
    s_cbranch_scc1 L_lbd_49
    s_sleep 1
    s_sub_u32 s64, s64, 1
    s_cbranch_scc0 L_lb_48
    s_mov_b32 s64, 7
    s_branch L_fail
L_lbd_49:
    ds_read_b128 v[168:171], v240 offset:8192
    ds_read_b128 v[172:175], v240 offset:9216
    ds_read_b128 v[176:179], v240 offset:10240
    ds_read_b128 v[180:183], v240 offset:11264
    ds_read_b128 v[184:187], v240 offset:12288
    ds_read_b128 v[188:191], v240 offset:13312
    ds_read_b128 v[192:195], v240 offset:14336
    ds_read_b128 v[196:199], v240 offset:15360
    s_setprio 0
    s_waitcnt lgkmcnt(7)
    v_mfma_f32_32x32x16_bf16 v[152:167], v[16:19], v[168:171], 0
    s_add_u32 m0, s70, 32768
    s_mov_b32 s71, 114688
    buffer_load_dwordx4 v245, s[44:47], s71 offen lds
    s_waitcnt lgkmcnt(6)
    v_mfma_f32_32x32x16_bf16 v[152:167], v[20:23], v[172:175], v[152:167]
    s_add_u32 m0, s70, 36864
    s_mov_b32 s71, 129024
    buffer_load_dwordx4 v245, s[44:47], s71 offen lds
    s_waitcnt lgkmcnt(5)
    v_mfma_f32_32x32x16_bf16 v[152:167], v[24:27], v[176:179], v[152:167]
    s_add_u32 m0, s70, 40960
    s_mov_b32 s71, 143360
    buffer_load_dwordx4 v245, s[44:47], s71 offen lds
    s_waitcnt lgkmcnt(4)
    v_mfma_f32_32x32x16_bf16 v[152:167], v[28:31], v[180:183], v[152:167]
    s_add_u32 m0, s70, 45056
    s_mov_b32 s71, 157696
    buffer_load_dwordx4 v245, s[44:47], s71 offen lds
    s_waitcnt lgkmcnt(3)
    v_mfma_f32_32x32x16_bf16 v[152:167], v[32:35], v[184:187], v[152:167]
    s_add_u32 m0, s70, 49152
    s_mov_b32 s71, 172032
    buffer_load_dwordx4 v245, s[44:47], s71 offen lds
    s_waitcnt lgkmcnt(2)
    v_mfma_f32_32x32x16_bf16 v[152:167], v[36:39], v[188:191], v[152:167]
    s_add_u32 m0, s70, 53248
    s_mov_b32 s71, 186368
    buffer_load_dwordx4 v245, s[44:47], s71 offen lds
    s_waitcnt lgkmcnt(1)
    v_mfma_f32_32x32x16_bf16 v[152:167], v[40:43], v[192:195], v[152:167]
    s_waitcnt lgkmcnt(0)
    v_mfma_f32_32x32x16_bf16 v[152:167], v[44:47], v[196:199], v[152:167]
    s_setprio 2
    s_lshl_b32 s66, s52, 12
    s_lshr_b32 s67, s83, 3
    s_lshl_b32 s67, s67, 7
    s_add_u32 s66, s66, s67
    s_add_u32 s66, s66, 8912896
    s_lshl_b32 s67, s61, 19
    s_add_u32 s66, s66, s67
    s_nop 3
    v_cvt_pk_bf16_f32 v200, v152, v160
    v_cvt_pk_bf16_f32 v201, v153, v161
    v_cvt_pk_bf16_f32 v202, v154, v162
    v_cvt_pk_bf16_f32 v203, v155, v163
    v_cvt_pk_bf16_f32 v204, v156, v164
    v_cvt_pk_bf16_f32 v205, v157, v165
    v_cvt_pk_bf16_f32 v206, v158, v166
    v_cvt_pk_bf16_f32 v207, v159, v167
    s_cmp_eq_u32 s52, 7
    s_cselect_b32 exec_lo, 1, -1
    s_cselect_b32 exec_hi, 1, -1
    s_setprio 0
    s_add_u32 s67, s66, 0
    buffer_store_dword v200, v243, s[24:27], s67 offen sc1
    s_add_u32 s67, s66, 32768
    buffer_store_dword v201, v243, s[24:27], s67 offen sc1
    s_add_u32 s67, s66, 65536
    buffer_store_dword v202, v243, s[24:27], s67 offen sc1
    s_add_u32 s67, s66, 98304
    buffer_store_dword v203, v243, s[24:27], s67 offen sc1
    s_add_u32 s67, s66, 262144
    buffer_store_dword v204, v243, s[24:27], s67 offen sc1
    s_add_u32 s67, s66, 294912
    buffer_store_dword v205, v243, s[24:27], s67 offen sc1
    s_add_u32 s67, s66, 327680
    buffer_store_dword v206, v243, s[24:27], s67 offen sc1
    s_add_u32 s67, s66, 360448
    buffer_store_dword v207, v243, s[24:27], s67 offen sc1
    s_setprio 2
    s_mov_b64 exec, -1
    s_waitcnt vmcnt(0)
    s_mov_b64 exec, 1
    ds_add_rtn_u32 v254, v14, v15 offset:8
    s_mov_b64 exec, -1
    s_waitcnt lgkmcnt(0)
    v_readfirstlane_b32 s66, v254
    s_cmp_eq_u32 s66, 7
    s_cbranch_scc0 L_arr_50
    s_mov_b32 s66, 1
    s_and_b32 s67, s2, 7
    s_lshl_b32 s67, s67, 7
    s_add_u32 s67, s67, 8
    s_atomic_add s66, s[74:75], s67 glc
    s_waitcnt lgkmcnt(0)
    s_sub_u32 s66, s66, s62
    s_cmp_eq_u32 s66, 31
    s_cbranch_scc0 L_arr_50
    s_mov_b32 s67, 8200
    buffer_atomic_add v15, v250, s[24:27], s67 offen sc1
    s_add_u32 s67, s67, 8192
    buffer_atomic_add v15, v250, s[24:27], s67 offen sc1
    s_add_u32 s67, s67, 8192
    s_mov_b64 exec, -1
L_arr_50:
    s_add_u32 s65, s65, 4
    s_mov_b64 exec, 1
    ds_add_u32 v14, v15
    s_mov_b64 exec, -1
    s_mov_b32 s64, 1048576
L_lb_51:
    ds_read_b32 v254, v14
    s_waitcnt lgkmcnt(0)
    v_readfirstlane_b32 s66, v254
    s_cmp_ge_u32 s66, s65
    s_cbranch_scc1 L_lbd_52
    s_sleep 1
    s_sub_u32 s64, s64, 1
    s_cbranch_scc0 L_lb_51
    s_mov_b32 s64, 4
    s_branch L_fail
L_lbd_52:
    ds_read_b64_tr_b16 v[72:73], v246 offset:0
    ds_read_b64_tr_b16 v[74:75], v246 offset:2048
    ds_read_b64_tr_b16 v[76:77], v246 offset:4096
    ds_read_b64_tr_b16 v[78:79], v247 offset:6144
    ds_read_b64_tr_b16 v[80:81], v246 offset:7168
    ds_read_b64_tr_b16 v[82:83], v246 offset:9216
    ds_read_b64_tr_b16 v[84:85], v246 offset:11264
    ds_read_b64_tr_b16 v[86:87], v247 offset:13312
    ds_read_b64_tr_b16 v[88:89], v246 offset:14336
    ds_read_b64_tr_b16 v[90:91], v246 offset:16384
    ds_read_b64_tr_b16 v[92:93], v246 offset:18432
    ds_read_b64_tr_b16 v[94:95], v247 offset:20480
    ds_read_b64_tr_b16 v[96:97], v246 offset:21504
    ds_read_b64_tr_b16 v[98:99], v246 offset:23552
    ds_read_b64_tr_b16 v[100:101], v246 offset:25600
    ds_read_b64_tr_b16 v[102:103], v247 offset:27648
    ds_read_b64_tr_b16 v[104:105], v246 offset:28672
    ds_read_b64_tr_b16 v[106:107], v246 offset:30720
    ds_read_b64_tr_b16 v[108:109], v246 offset:32768
    ds_read_b64_tr_b16 v[110:111], v247 offset:34816
    ds_read_b64_tr_b16 v[112:113], v246 offset:35840
    ds_read_b64_tr_b16 v[114:115], v246 offset:37888
    ds_read_b64_tr_b16 v[116:117], v246 offset:39936
    ds_read_b64_tr_b16 v[118:119], v247 offset:41984
    ds_read_b64_tr_b16 v[120:121], v246 offset:43008
    ds_read_b64_tr_b16 v[122:123], v246 offset:45056
    ds_read_b64_tr_b16 v[124:125], v246 offset:47104
    ds_read_b64_tr_b16 v[126:127], v247 offset:49152
    ds_read_b64_tr_b16 v[128:129], v246 offset:50176
    ds_read_b64_tr_b16 v[130:131], v246 offset:52224
    ds_read_b64_tr_b16 v[132:133], v246 offset:54272
    ds_read_b64_tr_b16 v[134:135], v247 offset:56320
    ds_read_b128 v[48:51], v7 offset:49152
    ds_read_b128 v[52:55], v7 offset:50176
    ds_read_b128 v[56:59], v7 offset:51200
    ds_read_b128 v[60:63], v7 offset:52224
    ds_read_b128 v[64:67], v7 offset:53248
    ds_read_b128 v[68:71], v7 offset:54272
    ds_read_b128 v[232:235], v7 offset:55296
    ds_read_b128 v[240:243], v7 offset:56320
    s_add_u32 s65, s65, 4
    s_mov_b64 exec, 1
    ds_add_u32 v14, v15
    s_mov_b64 exec, -1
    s_mov_b32 s64, 1048576
L_lb_53:
    ds_read_b32 v254, v14
    s_waitcnt lgkmcnt(0)
    v_readfirstlane_b32 s66, v254
    s_cmp_ge_u32 s66, s65
    s_cbranch_scc1 L_lbd_54
    s_sleep 1
    s_sub_u32 s64, s64, 1
    s_cbranch_scc0 L_lb_53
    s_mov_b32 s64, 24
    s_branch L_fail
L_lbd_54:
    s_setprio 0
    s_add_u32 m0, s70, 0
    s_mov_b32 s71, 200704
    buffer_load_dwordx4 v245, s[44:47], s71 offen lds
    s_add_u32 m0, s70, 4096
    s_mov_b32 s71, 215040
    buffer_load_dwordx4 v245, s[44:47], s71 offen lds
    s_add_u32 m0, s70, 8192
    s_mov_b32 s71, 229376
    buffer_load_dwordx4 v245, s[44:47], s71 offen lds
    s_add_u32 m0, s70, 12288
    s_mov_b32 s71, 243712
    buffer_load_dwordx4 v245, s[44:47], s71 offen lds
    s_add_u32 m0, s70, 16384
    s_mov_b32 s71, 258048
    buffer_load_dwordx4 v245, s[44:47], s71 offen lds
    s_add_u32 m0, s70, 20480
    s_mov_b32 s71, 272384
    buffer_load_dwordx4 v245, s[44:47], s71 offen lds
    s_add_u32 m0, s70, 24576
    s_mov_b32 s71, 286720
    buffer_load_dwordx4 v245, s[44:47], s71 offen lds
    s_add_u32 m0, s70, 28672
    s_mov_b32 s71, 301056
    buffer_load_dwordx4 v245, s[44:47], s71 offen lds
    s_add_u32 m0, s70, 32768
    s_mov_b32 s71, 315392
    buffer_load_dwordx4 v245, s[44:47], s71 offen lds
    s_add_u32 m0, s70, 36864
    s_mov_b32 s71, 329728
    buffer_load_dwordx4 v245, s[44:47], s71 offen lds
    s_add_u32 m0, s70, 40960
    s_mov_b32 s71, 344064
    buffer_load_dwordx4 v245, s[44:47], s71 offen lds
    s_add_u32 m0, s70, 45056
    s_mov_b32 s71, 358400
    buffer_load_dwordx4 v245, s[44:47], s71 offen lds
    s_add_u32 m0, s70, 49152
    s_mov_b32 s71, 372736
    buffer_load_dwordx4 v245, s[44:47], s71 offen lds
    s_add_u32 m0, s70, 53248
    s_mov_b32 s71, 387072
    buffer_load_dwordx4 v245, s[44:47], s71 offen lds
    s_setprio 2
    s_and_b32 s67, s2, 31
    s_mul_i32 s68, s61, 32
    s_add_u32 s67, s67, s68
    s_lshl_b32 s67, s67, 7
    s_add_u32 s67, s67, 4104
    s_mov_b32 s64, 131072
    s_add_u32 s68, s62, 8
    s_waitcnt lgkmcnt(0)
L_sw_55:
    s_mov_b32 s66, 0
    s_atomic_or s66, s[74:75], s67 glc
    s_waitcnt lgkmcnt(0)
    s_cmp_eq_u32 s66, s68
    s_cbranch_scc1 L_sw_55d
    s_sleep 2
    s_sub_u32 s64, s64, 1
    s_cbranch_scc0 L_sw_55
    s_mov_b32 s64, 32
    s_branch L_fail
L_sw_55d:
    s_lshl_b32 s66, s78, 15
    s_add_u32 s66, s66, 8912896
    s_lshl_b32 s67, s61, 12
    s_lshl_b32 s69, s73, 12
    s_add_u32 s68, s66, s69
    s_add_u32 s67, s66, s67
    s_setprio 0
    buffer_load_dword v16, v238, s[24:27], s67 offen offset:0 sc1
    buffer_load_dword v17, v238, s[24:27], s67 offen offset:128 sc1
    buffer_load_dword v18, v238, s[24:27], s67 offen offset:256 sc1
    buffer_load_dword v19, v238, s[24:27], s67 offen offset:384 sc1
    buffer_load_dword v20, v238, s[24:27], s67 offen offset:1024 sc1
    buffer_load_dword v21, v238, s[24:27], s67 offen offset:1152 sc1
    buffer_load_dword v22, v238, s[24:27], s67 offen offset:1280 sc1
    buffer_load_dword v23, v238, s[24:27], s67 offen offset:1408 sc1
    buffer_load_dword v24, v238, s[24:27], s67 offen offset:2048 sc1
    buffer_load_dword v25, v238, s[24:27], s67 offen offset:2176 sc1
    buffer_load_dword v26, v238, s[24:27], s67 offen offset:2304 sc1
    buffer_load_dword v27, v238, s[24:27], s67 offen offset:2432 sc1
    buffer_load_dword v28, v238, s[24:27], s67 offen offset:3072 sc1
    buffer_load_dword v29, v238, s[24:27], s67 offen offset:3200 sc1
    buffer_load_dword v30, v238, s[24:27], s67 offen offset:3328 sc1
    buffer_load_dword v31, v238, s[24:27], s67 offen offset:3456 sc1
    buffer_load_dword v32, v238, s[24:27], s68 offen offset:0 sc1
    buffer_load_dword v33, v238, s[24:27], s68 offen offset:128 sc1
    buffer_load_dword v34, v238, s[24:27], s68 offen offset:256 sc1
    buffer_load_dword v35, v238, s[24:27], s68 offen offset:384 sc1
    buffer_load_dword v36, v238, s[24:27], s68 offen offset:1024 sc1
    buffer_load_dword v37, v238, s[24:27], s68 offen offset:1152 sc1
    buffer_load_dword v38, v238, s[24:27], s68 offen offset:1280 sc1
    buffer_load_dword v39, v238, s[24:27], s68 offen offset:1408 sc1
    buffer_load_dword v40, v238, s[24:27], s68 offen offset:2048 sc1
    buffer_load_dword v41, v238, s[24:27], s68 offen offset:2176 sc1
    buffer_load_dword v42, v238, s[24:27], s68 offen offset:2304 sc1
    buffer_load_dword v43, v238, s[24:27], s68 offen offset:2432 sc1
    buffer_load_dword v44, v238, s[24:27], s68 offen offset:3072 sc1
    buffer_load_dword v45, v238, s[24:27], s68 offen offset:3200 sc1
    buffer_load_dword v46, v238, s[24:27], s68 offen offset:3328 sc1
    buffer_load_dword v47, v238, s[24:27], s68 offen offset:3456 sc1
    s_setprio 2
    s_waitcnt vmcnt(32)
    s_add_u32 s65, s65, 4
    s_mov_b64 exec, 1
    ds_add_u32 v14, v15
    s_mov_b64 exec, -1
    s_mov_b32 s64, 1048576
L_lb_58:
    ds_read_b32 v254, v14
    s_waitcnt lgkmcnt(0)
    v_readfirstlane_b32 s66, v254
    s_cmp_ge_u32 s66, s65
    s_cbranch_scc1 L_lbd_59
    s_sleep 1
    s_sub_u32 s64, s64, 1
    s_cbranch_scc0 L_lb_58
    s_mov_b32 s64, 10
    s_branch L_fail
L_lbd_59:
    ds_read_b64_tr_b16 v[136:137], v246 offset:0
    ds_read_b64_tr_b16 v[138:139], v246 offset:2048
    ds_read_b64_tr_b16 v[140:141], v246 offset:4096
    ds_read_b64_tr_b16 v[142:143], v247 offset:6144
    ds_read_b64_tr_b16 v[144:145], v246 offset:7168
    ds_read_b64_tr_b16 v[146:147], v246 offset:9216
    ds_read_b64_tr_b16 v[148:149], v246 offset:11264
    ds_read_b64_tr_b16 v[150:151], v247 offset:13312
    ds_read_b64_tr_b16 v[152:153], v246 offset:14336
    ds_read_b64_tr_b16 v[154:155], v246 offset:16384
    ds_read_b64_tr_b16 v[156:157], v246 offset:18432
    ds_read_b64_tr_b16 v[158:159], v247 offset:20480
    ds_read_b64_tr_b16 v[160:161], v246 offset:21504
    ds_read_b64_tr_b16 v[162:163], v246 offset:23552
    ds_read_b64_tr_b16 v[164:165], v246 offset:25600
    ds_read_b64_tr_b16 v[166:167], v247 offset:27648
    ds_read_b64_tr_b16 v[168:169], v246 offset:28672
    ds_read_b64_tr_b16 v[170:171], v246 offset:30720
    ds_read_b64_tr_b16 v[172:173], v246 offset:32768
    ds_read_b64_tr_b16 v[174:175], v247 offset:34816
    ds_read_b64_tr_b16 v[176:177], v246 offset:35840
    ds_read_b64_tr_b16 v[178:179], v246 offset:37888
    ds_read_b64_tr_b16 v[180:181], v246 offset:39936
    ds_read_b64_tr_b16 v[182:183], v247 offset:41984
    ds_read_b64_tr_b16 v[184:185], v246 offset:43008
    ds_read_b64_tr_b16 v[186:187], v246 offset:45056
    ds_read_b64_tr_b16 v[188:189], v246 offset:47104
    ds_read_b64_tr_b16 v[190:191], v247 offset:49152
    ds_read_b64_tr_b16 v[192:193], v246 offset:50176
    ds_read_b64_tr_b16 v[194:195], v246 offset:52224
    ds_read_b64_tr_b16 v[196:197], v246 offset:54272
    ds_read_b64_tr_b16 v[198:199], v247 offset:56320
    s_lshl_b32 s22, s78, 2
    s_add_u32 s22, s22, s61
    s_lshl_b32 s69, s22, 13
    s_add_u32 s69, s69, 4718592
    s_add_u32 s68, s69, 4096
    s_and_b32 s22, s78, 60
    s_add_u32 s22, s22, s61
    s_lshl_b32 s22, s22, 13
    s_and_b32 s67, s58, 3
    s_lshl_b32 s67, s67, 7
    s_add_u32 s22, s22, s67
    s_add_u32 s22, s22, 262144
    v_lshlrev_b32 v8, 11, v1
    s_lshl_b32 s67, s61, 13
    v_add_u32 v9, s67, v7
    s_waitcnt vmcnt(0)
    s_cmp_eq_u32 s61, 0
    s_cbranch_scc1 L_a3w0
    s_setprio 0
    v_mfma_f32_32x32x16_bf16 v[200:215], v[16:19], v[48:51], 0
    v_mfma_f32_32x32x16_bf16 v[216:231], v[16:19], v[52:55], 0
    v_mfma_f32_32x32x16_bf16 v[200:215], v[20:23], v[56:59], v[200:215]
    v_mfma_f32_32x32x16_bf16 v[216:231], v[20:23], v[60:63], v[216:231]
    v_mfma_f32_32x32x16_bf16 v[200:215], v[24:27], v[64:67], v[200:215]
    v_mfma_f32_32x32x16_bf16 v[216:231], v[24:27], v[68:71], v[216:231]
    v_mfma_f32_32x32x16_bf16 v[200:215], v[28:31], v[232:235], v[200:215]
    v_mfma_f32_32x32x16_bf16 v[216:231], v[28:31], v[240:243], v[216:231]
    s_setprio 2
    s_nop 9
    v_cvt_pk_bf16_f32 v16, v200, v201
    v_cvt_pk_bf16_f32 v17, v202, v203
    v_cvt_pk_bf16_f32 v18, v204, v205
    v_cvt_pk_bf16_f32 v19, v206, v207
    ds_write_b128 v248, v[16:19] offset:0
    v_cvt_pk_bf16_f32 v20, v208, v209
    v_cvt_pk_bf16_f32 v21, v210, v211
    v_cvt_pk_bf16_f32 v22, v212, v213
    v_cvt_pk_bf16_f32 v23, v214, v215
    ds_write_b128 v248, v[20:23] offset:1024
    v_cvt_pk_bf16_f32 v24, v216, v217
    v_cvt_pk_bf16_f32 v25, v218, v219
    v_cvt_pk_bf16_f32 v26, v220, v221
    v_cvt_pk_bf16_f32 v27, v222, v223
    ds_write_b128 v248, v[24:27] offset:2048
    v_cvt_pk_bf16_f32 v28, v224, v225
    v_cvt_pk_bf16_f32 v29, v226, v227
    v_cvt_pk_bf16_f32 v30, v228, v229
    v_cvt_pk_bf16_f32 v31, v230, v231
    ds_write_b128 v248, v[28:31] offset:3072
    v_mov_b32 v252, 0
    v_mov_b32 v253, 0
    s_bfm_b64 exec, 4, 0
    buffer_atomic_or_x2 v[252:253], v8, s[24:27], s22 offen sc0 sc1
    s_mov_b64 exec, -1
    s_setprio 0
    v_mfma_f32_32x32x16_bf16 v[200:215], v[32:35], v[48:51], 0
    v_mfma_f32_32x32x16_bf16 v[216:231], v[32:35], v[52:55], 0
    v_mfma_f32_32x32x16_bf16 v[200:215], v[36:39], v[56:59], v[200:215]
    v_mfma_f32_32x32x16_bf16 v[216:231], v[36:39], v[60:63], v[216:231]
    v_mfma_f32_32x32x16_bf16 v[200:215], v[40:43], v[64:67], v[200:215]
    v_mfma_f32_32x32x16_bf16 v[216:231], v[40:43], v[68:71], v[216:231]
    v_mfma_f32_32x32x16_bf16 v[200:215], v[44:47], v[232:235], v[200:215]
    v_mfma_f32_32x32x16_bf16 v[216:231], v[44:47], v[240:243], v[216:231]
    s_setprio 2
    s_nop 9
    v_cvt_pk_bf16_f32 v32, v200, v201
    v_cvt_pk_bf16_f32 v33, v202, v203
    v_cvt_pk_bf16_f32 v34, v204, v205
    v_cvt_pk_bf16_f32 v35, v206, v207
    ds_write_b128 v249, v[32:35] offset:0
    v_cvt_pk_bf16_f32 v36, v208, v209
    v_cvt_pk_bf16_f32 v37, v210, v211
    v_cvt_pk_bf16_f32 v38, v212, v213
    v_cvt_pk_bf16_f32 v39, v214, v215
    ds_write_b128 v249, v[36:39] offset:1024
    v_cvt_pk_bf16_f32 v40, v216, v217
    v_cvt_pk_bf16_f32 v41, v218, v219
    v_cvt_pk_bf16_f32 v42, v220, v221
    v_cvt_pk_bf16_f32 v43, v222, v223
    ds_write_b128 v249, v[40:43] offset:2048
    v_cvt_pk_bf16_f32 v44, v224, v225
    v_cvt_pk_bf16_f32 v45, v226, v227
    v_cvt_pk_bf16_f32 v46, v228, v229
    v_cvt_pk_bf16_f32 v47, v230, v231
    ds_write_b128 v249, v[44:47] offset:3072
    s_branch L_a3z
L_a3w0:
    s_mov_b32 exec_lo, -2
    s_mov_b32 exec_hi, -2
    v_mov_b32 v32, v16
    v_mov_b32 v33, v17
    v_mov_b32 v34, v18
    v_mov_b32 v35, v19
    v_mov_b32 v36, v20
    v_mov_b32 v37, v21
    v_mov_b32 v38, v22
    v_mov_b32 v39, v23
    v_mov_b32 v40, v24
    v_mov_b32 v41, v25
    v_mov_b32 v42, v26
    v_mov_b32 v43, v27
    v_mov_b32 v44, v28
    v_mov_b32 v45, v29
    v_mov_b32 v46, v30
    v_mov_b32 v47, v31
    s_mov_b64 exec, -1
    v_mov_b32 v252, 0
    v_mov_b32 v253, 0
    s_bfm_b64 exec, 4, 0
    buffer_atomic_or_x2 v[252:253], v8, s[24:27], s22 offen sc0 sc1
    s_mov_b64 exec, -1
    s_setprio 0
    v_mfma_f32_32x32x16_bf16 v[200:215], v[16:19], v[48:51], 0
    v_mfma_f32_32x32x16_bf16 v[216:231], v[32:35], v[52:55], 0
    v_mfma_f32_32x32x16_bf16 v[200:215], v[20:23], v[56:59], v[200:215]
    v_mfma_f32_32x32x16_bf16 v[216:231], v[36:39], v[60:63], v[216:231]
    v_mfma_f32_32x32x16_bf16 v[200:215], v[24:27], v[64:67], v[200:215]
    v_mfma_f32_32x32x16_bf16 v[216:231], v[40:43], v[68:71], v[216:231]
    v_mfma_f32_32x32x16_bf16 v[200:215], v[28:31], v[232:235], v[200:215]
    v_mfma_f32_32x32x16_bf16 v[216:231], v[44:47], v[240:243], v[216:231]
    s_setprio 2
    s_nop 9
    v_cvt_pk_bf16_f32 v16, v200, v201
    v_cvt_pk_bf16_f32 v17, v202, v203
    v_cvt_pk_bf16_f32 v18, v204, v205
    v_cvt_pk_bf16_f32 v19, v206, v207
    ds_write_b128 v248, v[16:19] offset:0
    v_cvt_pk_bf16_f32 v20, v208, v209
    v_cvt_pk_bf16_f32 v21, v210, v211
    v_cvt_pk_bf16_f32 v22, v212, v213
    v_cvt_pk_bf16_f32 v23, v214, v215
    ds_write_b128 v248, v[20:23] offset:1024
    v_cvt_pk_bf16_f32 v24, v216, v217
    v_cvt_pk_bf16_f32 v25, v218, v219
    v_cvt_pk_bf16_f32 v26, v220, v221
    v_cvt_pk_bf16_f32 v27, v222, v223
    ds_write_b128 v248, v[24:27] offset:2048
    v_cvt_pk_bf16_f32 v28, v224, v225
    v_cvt_pk_bf16_f32 v29, v226, v227
    v_cvt_pk_bf16_f32 v30, v228, v229
    v_cvt_pk_bf16_f32 v31, v230, v231
    ds_write_b128 v248, v[28:31] offset:3072
L_a3z:
    s_mov_b64 exec, 1
    ds_add_u32 v14, v15 offset:4
    s_mov_b64 exec, -1
    s_mov_b32 s71, 131072
    s_waitcnt vmcnt(0)
    v_cmp_ne_u64 vcc, s[62:63], v[252:253]
    s_and_b64 vcc, vcc, 0xf
    s_cbranch_scc0 L_aoload
    s_mov_b32 s64, 131072
L_poll_60:
    v_mov_b32 v252, 0
    v_mov_b32 v253, 0
    s_bfm_b64 exec, 4, 0
    buffer_atomic_or_x2 v[252:253], v8, s[24:27], s22 offen sc0 sc1
    s_mov_b64 exec, -1
    s_waitcnt vmcnt(0)
    v_cmp_ne_u64 vcc, s[62:63], v[252:253]
    s_and_b64 vcc, vcc, 0xf
    s_cbranch_scc0 L_polld_61
    s_sleep 2
    s_sub_u32 s64, s64, 1
    s_cbranch_scc0 L_poll_60
    s_mov_b32 s64, 42
    s_branch L_fail
L_polld_61:
L_aoload:
    buffer_load_dwordx4 v[16:19], v7, s[24:27], s69 offen offset:0 sc1
    buffer_load_dwordx4 v[20:23], v7, s[24:27], s69 offen offset:1024 sc1
    buffer_load_dwordx4 v[24:27], v7, s[24:27], s69 offen offset:2048 sc1
    buffer_load_dwordx4 v[28:31], v7, s[24:27], s69 offen offset:3072 sc1
    buffer_load_dwordx4 v[32:35], v7, s[24:27], s68 offen offset:0 sc1
    buffer_load_dwordx4 v[36:39], v7, s[24:27], s68 offen offset:1024 sc1
    buffer_load_dwordx4 v[40:43], v7, s[24:27], s68 offen offset:2048 sc1
    buffer_load_dwordx4 v[44:47], v7, s[24:27], s68 offen offset:3072 sc1
    s_mov_b32 s64, 1048576
L_lw_62:
    ds_read_b32 v254, v251 offset:0
    s_waitcnt lgkmcnt(0)
    v_readfirstlane_b32 s66, v254
    s_cmp_ge_u32 s66, 24
    s_cbranch_scc1 L_lwd_63
    s_sleep 1
    s_sub_u32 s64, s64, 1
    s_cbranch_scc0 L_lw_62
    s_mov_b32 s64, 43
    s_branch L_fail
L_lwd_63:
    s_waitcnt vmcnt(7)
    ds_write_b128 v9, v[16:19] offset:0
    s_waitcnt vmcnt(6)
    ds_write_b128 v9, v[20:23] offset:1024
    s_waitcnt vmcnt(5)
    ds_write_b128 v9, v[24:27] offset:2048
    v_max3_u32 v5, v16, v20, v24
    s_waitcnt vmcnt(4)
    ds_write_b128 v9, v[28:31] offset:3072
    s_waitcnt vmcnt(3)
    ds_write_b128 v9, v[32:35] offset:4096
    v_max3_u32 v5, v5, v28, v32
    s_waitcnt vmcnt(2)
    ds_write_b128 v9, v[36:39] offset:5120
    s_waitcnt vmcnt(1)
    ds_write_b128 v9, v[40:43] offset:6144
    v_max3_u32 v5, v5, v36, v40
    s_waitcnt vmcnt(0)
    ds_write_b128 v9, v[44:47] offset:7168
    v_max_u32 v5, v5, v44
    v_cmp_eq_u32 vcc, -1, v5
    s_cbranch_vccz L_aogot
    s_sleep 6
    s_sub_u32 s71, s71, 1
    s_cbranch_scc0 L_aoload
    s_mov_b32 s64, 44
    s_branch L_fail
L_aogot:
    s_mov_b64 exec, 1
    ds_add_u32 v251, v15 offset:20
    s_mov_b64 exec, -1
    s_mul_i32 s22, s78, 57344
    s_lshl_b32 s67, s82, 6
    s_add_u32 s22, s22, s67
    s_add_u32 s22, s22, 896
    s_add_u32 s69, s22, 28672
    s_mov_b32 s64, 1048576
L_lw_64:
    ds_read_b32 v254, v251 offset:20
    s_waitcnt lgkmcnt(0)
    v_readfirstlane_b32 s66, v254
    s_cmp_ge_u32 s66, 4
    s_cbranch_scc1 L_lwd_65
    s_sub_u32 s64, s64, 1
    s_cbranch_scc0 L_lw_64
    s_mov_b32 s64, 12
    s_branch L_fail
L_lwd_65:
    s_cmp_ge_u32 s61, s80
    s_cbranch_scc1 L_b3done
    ds_read_b128 v[216:219], v7 offset:0
    ds_read_b128 v[220:223], v7 offset:1024
    ds_read_b128 v[224:227], v7 offset:2048
    ds_read_b128 v[228:231], v7 offset:3072
    ds_read_b128 v[232:235], v7 offset:4096
    ds_read_b128 v[236:239], v7 offset:5120
    ds_read_b128 v[240:243], v7 offset:6144
    ds_read_b128 v[244:247], v7 offset:7168
    s_lshl_b32 s67, s61, 11
    s_add_u32 s67, s67, 86016
    v_lshlrev_b32 v10, 6, v2
    v_lshl_add_u32 v10, v3, 5, v10
    v_add_u32 v10, s67, v10
    v_add_u32 v11, s67, v7
    v_lshrrev_b32 v5, 2, v1
    v_mul_u32_u24 v5, 1792, v5
    v_and_b32 v12, 3, v1
    v_lshl_add_u32 v5, v12, 4, v5
    s_waitcnt lgkmcnt(7)
    v_mfma_f32_32x32x16_bf16 v[200:215], v[72:75], v[216:219], 0
    ds_read_b128 v[216:219], v7 offset:8192
    s_waitcnt lgkmcnt(7)
    v_mfma_f32_32x32x16_bf16 v[200:215], v[76:79], v[220:223], v[200:215]
    ds_read_b128 v[220:223], v7 offset:9216
    s_waitcnt lgkmcnt(7)
    v_mfma_f32_32x32x16_bf16 v[200:215], v[80:83], v[224:227], v[200:215]
    ds_read_b128 v[224:227], v7 offset:10240
    s_waitcnt lgkmcnt(7)
    v_mfma_f32_32x32x16_bf16 v[200:215], v[84:87], v[228:231], v[200:215]
    ds_read_b128 v[228:231], v7 offset:11264
    s_waitcnt lgkmcnt(7)
    v_mfma_f32_32x32x16_bf16 v[200:215], v[88:91], v[232:235], v[200:215]
    ds_read_b128 v[232:235], v7 offset:12288
    s_waitcnt lgkmcnt(7)
    v_mfma_f32_32x32x16_bf16 v[200:215], v[92:95], v[236:239], v[200:215]
    ds_read_b128 v[236:239], v7 offset:13312
    s_waitcnt lgkmcnt(7)
    v_mfma_f32_32x32x16_bf16 v[200:215], v[96:99], v[240:243], v[200:215]
    ds_read_b128 v[240:243], v7 offset:14336
    s_waitcnt lgkmcnt(7)
    v_mfma_f32_32x32x16_bf16 v[200:215], v[100:103], v[244:247], v[200:215]
    ds_read_b128 v[244:247], v7 offset:15360
    s_waitcnt lgkmcnt(7)
    v_mfma_f32_32x32x16_bf16 v[200:215], v[104:107], v[216:219], v[200:215]
    ds_read_b128 v[216:219], v7 offset:16384
    s_waitcnt lgkmcnt(7)
    v_mfma_f32_32x32x16_bf16 v[200:215], v[108:111], v[220:223], v[200:215]
    ds_read_b128 v[220:223], v7 offset:17408
    s_waitcnt lgkmcnt(7)
    v_mfma_f32_32x32x16_bf16 v[200:215], v[112:115], v[224:227], v[200:215]
    ds_read_b128 v[224:227], v7 offset:18432
    s_waitcnt lgkmcnt(7)
    v_mfma_f32_32x32x16_bf16 v[200:215], v[116:119], v[228:231], v[200:215]
    ds_read_b128 v[228:231], v7 offset:19456
    s_waitcnt lgkmcnt(7)
    v_mfma_f32_32x32x16_bf16 v[200:215], v[120:123], v[232:235], v[200:215]
    ds_read_b128 v[232:235], v7 offset:20480
    s_waitcnt lgkmcnt(7)
    v_mfma_f32_32x32x16_bf16 v[200:215], v[124:127], v[236:239], v[200:215]
    ds_read_b128 v[236:239], v7 offset:21504
    s_waitcnt lgkmcnt(7)
    v_mfma_f32_32x32x16_bf16 v[200:215], v[128:131], v[240:243], v[200:215]
    ds_read_b128 v[240:243], v7 offset:22528
    s_waitcnt lgkmcnt(7)
    v_mfma_f32_32x32x16_bf16 v[200:215], v[132:135], v[244:247], v[200:215]
    ds_read_b128 v[244:247], v7 offset:23552
    s_waitcnt lgkmcnt(7)
    v_mfma_f32_32x32x16_bf16 v[200:215], v[136:139], v[216:219], v[200:215]
    ds_read_b128 v[216:219], v7 offset:24576
    s_waitcnt lgkmcnt(7)
    v_mfma_f32_32x32x16_bf16 v[200:215], v[140:143], v[220:223], v[200:215]
    ds_read_b128 v[220:223], v7 offset:25600
    s_waitcnt lgkmcnt(7)
    v_mfma_f32_32x32x16_bf16 v[200:215], v[144:147], v[224:227], v[200:215]
    ds_read_b128 v[224:227], v7 offset:26624
    s_waitcnt lgkmcnt(7)
    v_mfma_f32_32x32x16_bf16 v[200:215], v[148:151], v[228:231], v[200:215]
    ds_read_b128 v[228:231], v7 offset:27648
    s_waitcnt lgkmcnt(7)
    v_mfma_f32_32x32x16_bf16 v[200:215], v[152:155], v[232:235], v[200:215]
    ds_read_b128 v[232:235], v7 offset:28672
    s_waitcnt lgkmcnt(7)
    v_mfma_f32_32x32x16_bf16 v[200:215], v[156:159], v[236:239], v[200:215]
    ds_read_b128 v[236:239], v7 offset:29696
    s_waitcnt lgkmcnt(7)
    v_mfma_f32_32x32x16_bf16 v[200:215], v[160:163], v[240:243], v[200:215]
    ds_read_b128 v[240:243], v7 offset:30720
    s_waitcnt lgkmcnt(7)
    v_mfma_f32_32x32x16_bf16 v[200:215], v[164:167], v[244:247], v[200:215]
    ds_read_b128 v[244:247], v7 offset:31744
    s_waitcnt lgkmcnt(7)
    v_mfma_f32_32x32x16_bf16 v[200:215], v[168:171], v[216:219], v[200:215]
    s_waitcnt lgkmcnt(6)
    v_mfma_f32_32x32x16_bf16 v[200:215], v[172:175], v[220:223], v[200:215]
    s_waitcnt lgkmcnt(5)
    v_mfma_f32_32x32x16_bf16 v[200:215], v[176:179], v[224:227], v[200:215]
    s_waitcnt lgkmcnt(4)
    v_mfma_f32_32x32x16_bf16 v[200:215], v[180:183], v[228:231], v[200:215]
    s_waitcnt lgkmcnt(3)
    v_mfma_f32_32x32x16_bf16 v[200:215], v[184:187], v[232:235], v[200:215]
    s_waitcnt lgkmcnt(2)
    v_mfma_f32_32x32x16_bf16 v[200:215], v[188:191], v[236:239], v[200:215]
    s_waitcnt lgkmcnt(1)
    v_mfma_f32_32x32x16_bf16 v[200:215], v[192:195], v[240:243], v[200:215]
    s_waitcnt lgkmcnt(0)
    v_mfma_f32_32x32x16_bf16 v[200:215], v[196:199], v[244:247], v[200:215]
    s_nop 11
    v_cvt_pk_bf16_f32 v48, v200, v201
    v_cvt_pk_bf16_f32 v49, v202, v203
    v_cvt_pk_bf16_f32 v50, v204, v205
    v_cvt_pk_bf16_f32 v51, v206, v207
    ds_write_b128 v10, v[48:51] offset:0
    v_cvt_pk_bf16_f32 v52, v208, v209
    v_cvt_pk_bf16_f32 v53, v210, v211
    v_cvt_pk_bf16_f32 v54, v212, v213
    v_cvt_pk_bf16_f32 v55, v214, v215
    ds_write_b128 v10, v[52:55] offset:16
    ds_read_b128 v[56:59], v11
    ds_read_b128 v[60:63], v11 offset:1024
    s_waitcnt lgkmcnt(1)
    buffer_store_dwordx4 v[56:59], v5, s[48:51], s22 offen sc0 sc1
    s_waitcnt lgkmcnt(0)
    buffer_store_dwordx4 v[60:63], v5, s[48:51], s69 offen sc0 sc1
L_b3done:
    s_lshl_b32 s66, s2, 2
    s_add_u32 s66, s66, s61
    s_cmp_lg_u32 s66, 0
    s_cbranch_scc1 L_noep
    s_mov_b32 s66, 0
    v_mov_b32 v10, s62
    v_mov_b32 v11, s63
    v_mov_b32 v12, 0
    s_mov_b64 exec, 1
    buffer_store_dwordx2 v[10:11], v12, s[24:27], s66 offen sc1
    s_mov_b64 exec, -1
L_noep:
    s_endpgm
L_fail:
    v_mov_b32 v0, 0
    v_mov_b32 v1, s64
    global_store_dword v0, v1, s[18:19]
L_end:
    s_endpgm
L_codeend:
.section .rodata,"a"
.p2align 6
.amdhsa_kernel concat_heads__spectral_gfnet__softmax_full_mha__prompt_kernel
  .amdhsa_next_free_vgpr 256
  .amdhsa_next_free_sgpr 102
  .amdhsa_accum_offset 256
  .amdhsa_group_segment_fixed_size 0
  .amdhsa_kernarg_size 72
  .amdhsa_user_sgpr_count 2
  .amdhsa_user_sgpr_kernarg_segment_ptr 1
  .amdhsa_system_sgpr_workgroup_id_x 1
.end_amdhsa_kernel
```
